```python
import torch

def _softmax(x, axis=-1):
    return torch.softmax(x, dim=axis)
def _gelu(x):
    return torch.nn.functional.gelu(x, approximate="tanh")
def _silu(x):
    return torch.nn.functional.silu(x)
def _sigmoid(x):
    return torch.sigmoid(x)
def _layernorm(x, axis=-1, eps=1e-5):
    m = x.mean(dim=axis, keepdim=True)
    v = x.var(dim=axis, keepdim=True, unbiased=False)
    return (x - m) / torch.sqrt(v + eps)
def _scatter_add(tgt, idx, src, axis=0):
    return tgt.clone().index_add_(axis, idx, src)
def _segment_sum(src, seg, n):
    out = torch.zeros((n,) + src.shape[1:], dtype=src.dtype)
    return out.index_add_(0, seg, src)
def _pad(x, pw):
    flat = tuple(v for pair in reversed(pw) for v in pair)
    return torch.nn.functional.pad(x, flat)

kernel_name = 'parallel_sum__mha_block_cached__glu_gated_geglu__decode'

def setup_inputs():

    _w = (lambda a: (lambda t: t.to(torch.bfloat16) if t.is_floating_point() else t)(torch.as_tensor(a)))
    def _A_setup():
        B, Sq, D = 1, 1, 1024
        H, Sk, Dh = 32, 65536, 128
        return {
            "x": _w((lambda *s: torch.randn(*s, dtype=torch.bfloat16) * 0.05)(B, Sq, D)),
            "k_cache": _w((lambda *s: torch.randn(*s, dtype=torch.bfloat16) * 3.2)(B, H, Sk, Dh)),
            "v_cache": _w((lambda *s: torch.randn(*s, dtype=torch.bfloat16) * 1.6)(B, H, Sk, Dh)),
            "wq": _w((lambda *s: torch.randn(*s, dtype=torch.bfloat16) * 3.2)(D, H * Dh) * (D ** -0.5)),
            "wo": _w((lambda *s: torch.randn(*s, dtype=torch.bfloat16) * 1.6)(H * Dh, D) * ((H * Dh) ** -0.5)),
        }
    _A_in = _A_setup()

    def _B_setup():
        B, S, Dm, Df = 1, 1, 1024, 3584
        return {
            "x": _w((lambda *s: torch.randn(*s, dtype=torch.bfloat16) * 0.05)(B, S, Dm)),
            "w_gate": _w((lambda *s: torch.randn(*s, dtype=torch.bfloat16) * 1.6)(Dm, Df) * (Dm ** -0.5)),
            "w_up": _w((lambda *s: torch.randn(*s, dtype=torch.bfloat16) * 1.6)(Dm, Df) * (Dm ** -0.5)),
            "w_down": _w((lambda *s: torch.randn(*s, dtype=torch.bfloat16) * 1.6)(Df, Dm) * (Df ** -0.5)),
        }
    _B_in = _B_setup()

    return {
        "A_x": _A_in["x"],
        "A_k_cache": _A_in["k_cache"],
        "A_v_cache": _A_in["v_cache"],
        "A_wq": _A_in["wq"],
        "A_wo": _A_in["wo"],
        "B_x": _B_in["x"],
        "B_w_gate": _B_in["w_gate"],
        "B_w_up": _B_in["w_up"],
        "B_w_down": _B_in["w_down"],
    }

def reference(A_x, A_k_cache, A_v_cache, A_wq, A_wo, B_x, B_w_gate, B_w_up, B_w_down):
    def _A_ref(x, k_cache, v_cache, wq, wo):
        B, Sq, D = x.shape
        H, Dh = 32, 128
        q = (lambda x, *d: x.permute(*d))((x @ wq).reshape(B, Sq, H, Dh), 0, 2, 1, 3)
        scores = torch.einsum("bhqd,bhkd->bhqk", q, k_cache) * (Dh ** -0.5)
        p = _softmax(scores, axis=-1)
        o = torch.einsum("bhqk,bhkd->bhqd", p, v_cache)
        return (lambda x, *d: x.permute(*d))(o, 0, 2, 1, 3).reshape(B, Sq, H * Dh) @ wo

    def _B_ref(x, w_gate, w_up, w_down):
        g = torch.einsum("bsd,df->bsf", x, w_gate)
        u = torch.einsum("bsd,df->bsf", x, w_up)
        h = _gelu(g) * u
        return torch.einsum("bsf,fd->bsd", h, w_down)

    x = A_x
    xn = _layernorm(x, axis=-1)
    return x + _A_ref(xn, A_k_cache, A_v_cache, A_wq, A_wo) + _B_ref(xn, B_w_gate, B_w_up, B_w_down)
```

```asm
; @launch grid=(256,1,1) block=(192,1,1) lds=38720
.amdgcn_target "amdgcn-amd-amdhsa--gfx950"
.text
.globl parallel_sum__mha_block_cached__glu_gated_geglu__decode_kernel
.p2align 8
.type parallel_sum__mha_block_cached__glu_gated_geglu__decode_kernel,@function
parallel_sum__mha_block_cached__glu_gated_geglu__decode_kernel:
  s_cmp_ge_u32 s2, 256
  s_cbranch_scc1 L_end
  s_load_dwordx16 s[36:51], s[0:1], 0
  s_load_dwordx8 s[52:59], s[0:1], 64
  s_getpc_b64 s[32:33]
L_pc:
  v_lshlrev_b32 v54, 7, v0
  v_min_u32 v54, L_codeend-L_pc-4, v54
  global_load_dword v52, v54, s[32:33]
  s_memrealtime s[34:35]
  v_lshrrev_b32 v1, 6, v0
  v_and_b32 v0, 63, v0
  s_lshr_b32 s4, s2, 3
  v_readfirstlane_b32 s3, v1
  s_and_b32 s5, s2, 7
  s_mov_b32 s79, s2
  v_lshlrev_b32 v1, 4, v0
  v_add_u32 v2, 4096, v1
  v_lshlrev_b32 v17, 5, v0
  v_and_b32 v19, 15, v0
  v_lshrrev_b32 v20, 4, v0
  v_and_b32 v21, 7, v0
  v_and_b32 v18, 56, v0
  v_lshl_add_u32 v18, v21, 6, v18
  v_and_b32 v201, 16, v0
  v_lshl_add_u32 v201, v21, 5, v201
  v_lshrrev_b32 v21, 5, v0
  v_lshl_add_u32 v201, v21, 8, v201
  s_mov_b32 s71, s4
  s_mov_b32 s77, s5
  s_mov_b32 s76, 0xffff0000
  v_and_b32 v21, 1, v20
  v_lshl_add_u32 v55, v19, 1, v21
  v_lshlrev_b32 v55, 4, v55
  v_and_b32 v21, 3, v19
  v_cmp_eq_u32 vcc, 3, v21
  v_mov_b32 v22, 0xffff
  v_mov_b32 v23, s76
  v_cndmask_b32 v22, v22, v23, vcc
  v_cndmask_b32_e64 v21, v21, 0, vcc
  v_or_b32 v21, 12, v21
  v_mul_u32_u24 v198, 0x1111, v21
  v_lshl_or_b32 v198, v198, 16, v198
  v_lshrrev_b32 v21, 2, v19
  v_mov_b32 v200, v22
  v_mov_b32 v24, 0
  v_mov_b32 v25, 0
  v_mov_b32 v26, 0
  v_mov_b32 v27, 0
  v_cmp_eq_u32 vcc, 0, v21
  s_nop 1
  v_cndmask_b32 v196, 0, v22, vcc
  v_cmp_eq_u32 vcc, 1, v21
  s_nop 1
  v_cndmask_b32 v197, 0, v22, vcc
  v_mov_b32 v54, 0
  v_mov_b32 v194, 0xff
  s_cmp_eq_u32 s3, 2
  s_cselect_b32 s65, s5, s77
  s_and_b32 s65, s65, 6
  s_lshl_b32 s65, s65, 8
  s_waitcnt lgkmcnt(0)
  s_mov_b32 s16, s36
  s_mov_b32 s17, s37
  s_mov_b32 s18, 2048
  s_mov_b32 s19, 0x20000
  buffer_load_dwordx4 v[8:11], v17, s[16:19], 0 offen
  buffer_load_dwordx4 v[12:15], v17, s[16:19], 0 offen offset:16
  buffer_load_dwordx2 v[202:203], v18, s[16:19], s65 offen
  s_mov_b32 s20, s58
  s_mov_b32 s21, s59
  s_mov_b32 s22, 4194304
  s_mov_b32 s23, 0x20000
  s_cmp_lg_u32 s3, 2
  s_cbranch_scc1 L_stream
  s_mov_b32 s24, s42
  s_mov_b32 s25, s43
  s_mov_b32 s26, 8388608
  s_mov_b32 s27, 0x20000
  v_lshrrev_b32 v3, 3, v0
  v_lshlrev_b32 v3, 15, v3
  v_and_b32 v21, 7, v0
  v_lshl_add_u32 v3, v21, 4, v3
  s_lshr_b32 s69, s5, 1
  s_lshl_b32 s69, s69, 21
  s_lshl_b32 s67, s4, 8
  s_add_u32 s69, s69, s67
  s_and_b32 s67, s5, 1
  s_lshl_b32 s67, s67, 7
  s_add_u32 s69, s69, s67
  buffer_load_dwordx4 v[56:59], v3, s[24:27], s69 offen nt
  s_add_u32 s69, s69, 8192
  buffer_load_dwordx4 v[60:63], v3, s[24:27], s69 offen nt
  s_add_u32 s69, s69, 8192
  buffer_load_dwordx4 v[64:67], v3, s[24:27], s69 offen nt
  s_add_u32 s69, s69, 8192
  buffer_load_dwordx4 v[68:71], v3, s[24:27], s69 offen nt
  s_add_u32 s69, s69, 237568
  buffer_load_dwordx4 v[72:75], v3, s[24:27], s69 offen nt
  s_add_u32 s69, s69, 8192
  buffer_load_dwordx4 v[76:79], v3, s[24:27], s69 offen nt
  s_add_u32 s69, s69, 8192
  buffer_load_dwordx4 v[80:83], v3, s[24:27], s69 offen nt
  s_add_u32 s69, s69, 8192
  buffer_load_dwordx4 v[84:87], v3, s[24:27], s69 offen nt
  s_add_u32 s69, s69, 237568
  buffer_load_dwordx4 v[88:91], v3, s[24:27], s69 offen nt
  s_add_u32 s69, s69, 8192
  buffer_load_dwordx4 v[92:95], v3, s[24:27], s69 offen nt
  s_add_u32 s69, s69, 8192
  buffer_load_dwordx4 v[96:99], v3, s[24:27], s69 offen nt
  s_add_u32 s69, s69, 8192
  buffer_load_dwordx4 v[100:103], v3, s[24:27], s69 offen nt
  s_add_u32 s69, s69, 237568
  buffer_load_dwordx4 v[104:107], v3, s[24:27], s69 offen nt
  s_add_u32 s69, s69, 8192
  buffer_load_dwordx4 v[108:111], v3, s[24:27], s69 offen nt
  s_add_u32 s69, s69, 8192
  buffer_load_dwordx4 v[112:115], v3, s[24:27], s69 offen nt
  s_add_u32 s69, s69, 8192
  buffer_load_dwordx4 v[116:119], v3, s[24:27], s69 offen nt
  s_add_u32 s69, s69, 237568
  buffer_load_dwordx4 v[120:123], v3, s[24:27], s69 offen nt
  s_add_u32 s69, s69, 8192
  buffer_load_dwordx4 v[124:127], v3, s[24:27], s69 offen nt
  s_add_u32 s69, s69, 8192
  buffer_load_dwordx4 v[128:131], v3, s[24:27], s69 offen nt
  s_add_u32 s69, s69, 8192
  buffer_load_dwordx4 v[132:135], v3, s[24:27], s69 offen nt
  s_add_u32 s69, s69, 237568
  buffer_load_dwordx4 v[136:139], v3, s[24:27], s69 offen nt
  s_add_u32 s69, s69, 8192
  buffer_load_dwordx4 v[140:143], v3, s[24:27], s69 offen nt
  s_add_u32 s69, s69, 8192
  buffer_load_dwordx4 v[144:147], v3, s[24:27], s69 offen nt
  s_add_u32 s69, s69, 8192
  buffer_load_dwordx4 v[148:151], v3, s[24:27], s69 offen nt
  s_add_u32 s69, s69, 237568
  buffer_load_dwordx4 v[152:155], v3, s[24:27], s69 offen nt
  s_add_u32 s69, s69, 8192
  buffer_load_dwordx4 v[156:159], v3, s[24:27], s69 offen nt
  s_add_u32 s69, s69, 8192
  buffer_load_dwordx4 v[160:163], v3, s[24:27], s69 offen nt
  s_add_u32 s69, s69, 8192
  buffer_load_dwordx4 v[164:167], v3, s[24:27], s69 offen nt
  s_add_u32 s69, s69, 237568
  buffer_load_dwordx4 v[168:171], v3, s[24:27], s69 offen nt
  s_add_u32 s69, s69, 8192
  buffer_load_dwordx4 v[172:175], v3, s[24:27], s69 offen nt
  s_add_u32 s69, s69, 8192
  buffer_load_dwordx4 v[176:179], v3, s[24:27], s69 offen nt
  s_add_u32 s69, s69, 8192
  buffer_load_dwordx4 v[180:183], v3, s[24:27], s69 offen nt
  s_barrier
  s_load_dword s60, s[58:59], 0
  v_mov_b32 v193, 7
  v_mov_b32 v199, 132
  v_lshlrev_b32 v21, 2, v0
  ds_write_b32 v21, v54 offset:4672
  ds_write_b32 v21, v54 offset:4928
  ds_write_b32 v21, v54 offset:5184
  ds_write_b32 v21, v54 offset:5440
  ds_write_b32 v21, v54 offset:5696
  ds_write_b32 v21, v54 offset:256
  s_waitcnt vmcnt(32)
  v_lshlrev_b32 v40, 16, v8
  v_and_b32 v8, s76, v8
  v_lshlrev_b32 v41, 16, v9
  v_and_b32 v9, s76, v9
  v_lshlrev_b32 v42, 16, v10
  v_and_b32 v10, s76, v10
  v_lshlrev_b32 v43, 16, v11
  v_and_b32 v11, s76, v11
  v_lshlrev_b32 v44, 16, v12
  v_and_b32 v12, s76, v12
  v_lshlrev_b32 v45, 16, v13
  v_and_b32 v13, s76, v13
  v_lshlrev_b32 v46, 16, v14
  v_and_b32 v14, s76, v14
  v_lshlrev_b32 v47, 16, v15
  v_and_b32 v15, s76, v15
  v_add_f32 v17, v40, v8
  v_add_f32 v18, v41, v9
  v_add_f32 v17, v17, v18
  v_add_f32 v18, v42, v10
  v_add_f32 v17, v17, v18
  v_add_f32 v18, v43, v11
  v_add_f32 v17, v17, v18
  v_add_f32 v18, v44, v12
  v_add_f32 v17, v17, v18
  v_add_f32 v18, v45, v13
  v_add_f32 v17, v17, v18
  v_add_f32 v18, v46, v14
  v_add_f32 v17, v17, v18
  v_add_f32 v18, v47, v15
  v_add_f32 v17, v17, v18
  s_nop 1
  v_add_f32_dpp v17, v17, v17 quad_perm:[1,0,3,2] row_mask:0xf bank_mask:0xf
  s_nop 1
  v_add_f32_dpp v17, v17, v17 quad_perm:[2,3,0,1] row_mask:0xf bank_mask:0xf
  s_nop 1
  v_add_f32_dpp v17, v17, v17 row_half_mirror row_mask:0xf bank_mask:0xf
  s_nop 1
  v_add_f32_dpp v17, v17, v17 row_mirror row_mask:0xf bank_mask:0xf
  s_nop 0
  v_readlane_b32 s65, v17, 0
  v_readlane_b32 s66, v17, 16
  v_readlane_b32 s67, v17, 32
  v_readlane_b32 s68, v17, 48
  s_nop 0
  v_mov_b32 v17, s65
  v_add_f32 v17, s66, v17
  v_add_f32 v17, s67, v17
  v_add_f32 v17, s68, v17
  v_mul_f32 v17, 0x3a800000, v17
  v_mov_b32 v18, 0
  v_sub_f32 v40, v40, v17
  v_sub_f32 v8, v8, v17
  v_fmac_f32 v18, v40, v40
  v_fmac_f32 v18, v8, v8
  v_sub_f32 v41, v41, v17
  v_sub_f32 v9, v9, v17
  v_fmac_f32 v18, v41, v41
  v_fmac_f32 v18, v9, v9
  v_sub_f32 v42, v42, v17
  v_sub_f32 v10, v10, v17
  v_fmac_f32 v18, v42, v42
  v_fmac_f32 v18, v10, v10
  v_sub_f32 v43, v43, v17
  v_sub_f32 v11, v11, v17
  v_fmac_f32 v18, v43, v43
  v_fmac_f32 v18, v11, v11
  v_sub_f32 v44, v44, v17
  v_sub_f32 v12, v12, v17
  v_fmac_f32 v18, v44, v44
  v_fmac_f32 v18, v12, v12
  v_sub_f32 v45, v45, v17
  v_sub_f32 v13, v13, v17
  v_fmac_f32 v18, v45, v45
  v_fmac_f32 v18, v13, v13
  v_sub_f32 v46, v46, v17
  v_sub_f32 v14, v14, v17
  v_fmac_f32 v18, v46, v46
  v_fmac_f32 v18, v14, v14
  v_sub_f32 v47, v47, v17
  v_sub_f32 v15, v15, v17
  v_fmac_f32 v18, v47, v47
  v_fmac_f32 v18, v15, v15
  s_nop 1
  v_add_f32_dpp v18, v18, v18 quad_perm:[1,0,3,2] row_mask:0xf bank_mask:0xf
  s_nop 1
  v_add_f32_dpp v18, v18, v18 quad_perm:[2,3,0,1] row_mask:0xf bank_mask:0xf
  s_nop 1
  v_add_f32_dpp v18, v18, v18 row_half_mirror row_mask:0xf bank_mask:0xf
  s_nop 1
  v_add_f32_dpp v18, v18, v18 row_mirror row_mask:0xf bank_mask:0xf
  s_nop 0
  v_readlane_b32 s65, v18, 0
  v_readlane_b32 s66, v18, 16
  v_readlane_b32 s67, v18, 32
  v_readlane_b32 s68, v18, 48
  s_nop 0
  v_mov_b32 v18, s65
  v_add_f32 v18, s66, v18
  v_add_f32 v18, s67, v18
  v_add_f32 v18, s68, v18
  v_mul_f32 v18, 0x3a800000, v18
  v_cvt_pk_bf16_f32 v17, v17, v17
  v_and_b32 v17, s76, v17
  v_cvt_pk_bf16_f32 v18, v18, v18
  v_and_b32 v18, s76, v18
  v_add_f32 v18, 0x3727c5ac, v18
  v_cvt_pk_bf16_f32 v18, v18, v18
  v_and_b32 v18, s76, v18
  v_sqrt_f32 v18, v18
  s_nop 0
  v_cvt_pk_bf16_f32 v18, v18, v18
  v_and_b32 v18, s76, v18
  v_rcp_f32 v18, v18
  v_lshlrev_b32 v4, 16, v202
  v_and_b32 v5, s76, v202
  v_lshlrev_b32 v6, 16, v203
  v_and_b32 v7, s76, v203
  v_sub_f32 v4, v4, v17
  v_sub_f32 v5, v5, v17
  v_sub_f32 v6, v6, v17
  v_sub_f32 v7, v7, v17
  v_cvt_pk_bf16_f32 v4, v4, v4
  v_and_b32 v4, s76, v4
  v_cvt_pk_bf16_f32 v5, v5, v5
  v_and_b32 v5, s76, v5
  v_cvt_pk_bf16_f32 v6, v6, v6
  v_and_b32 v6, s76, v6
  v_cvt_pk_bf16_f32 v7, v7, v7
  v_and_b32 v7, s76, v7
  v_mul_f32 v4, v4, v18
  v_mul_f32 v5, v5, v18
  v_mul_f32 v6, v6, v18
  v_mul_f32 v7, v7, v18
  v_cvt_pk_bf16_f32 v4, v4, v4
  v_cvt_pk_bf16_f32 v5, v5, v5
  v_cvt_pk_bf16_f32 v6, v6, v6
  v_cvt_pk_bf16_f32 v7, v7, v7
  s_waitcnt lgkmcnt(0)
  s_add_u32 s60, s60, 0x9e3779b9
  v_mov_b32 v192, s60
  s_lshl_b32 s65, s34, 4
  s_add_u32 s65, s65, 6800
  v_mov_b32 v19, 1710
  v_mov_b32 v18, s65
  ds_write_b32 v54, v192 offset:256
  ds_write_b64 v54, v[18:19] offset:264
  s_lshl_b32 s65, s2, 8
  s_add_u32 s65, s65, 65536
  s_lshl_b32 s69, s4, 11
  s_add_u32 s69, s69, 65536
  v_mov_b32 v28, 0
  v_mov_b32 v29, 0
  v_mov_b32 v30, 0
  v_mov_b32 v31, 0
  v_and_b32_dpp v24, v4, v200 row_newbcast:0 row_mask:0xf bank_mask:0x1
  v_and_b32_dpp v25, v4, v200 row_newbcast:0 row_mask:0xf bank_mask:0x2
  v_and_b32_dpp v24, v4, v200 row_newbcast:8 row_mask:0xf bank_mask:0x4
  v_and_b32_dpp v25, v4, v200 row_newbcast:8 row_mask:0xf bank_mask:0x8
  v_and_b32_dpp v26, v5, v200 row_newbcast:0 row_mask:0xf bank_mask:0x1
  v_and_b32_dpp v27, v5, v200 row_newbcast:0 row_mask:0xf bank_mask:0x2
  v_and_b32_dpp v26, v5, v200 row_newbcast:8 row_mask:0xf bank_mask:0x4
  v_and_b32_dpp v27, v5, v200 row_newbcast:8 row_mask:0xf bank_mask:0x8
  s_waitcnt vmcnt(31)
  v_smfmac_f32_16x16x32_bf16 v[28:31], v[24:25], v[56:59], v198
  v_and_b32_dpp v24, v6, v200 row_newbcast:0 row_mask:0xf bank_mask:0x1
  v_and_b32_dpp v25, v6, v200 row_newbcast:0 row_mask:0xf bank_mask:0x2
  v_and_b32_dpp v24, v6, v200 row_newbcast:8 row_mask:0xf bank_mask:0x4
  v_and_b32_dpp v25, v6, v200 row_newbcast:8 row_mask:0xf bank_mask:0x8
  s_waitcnt vmcnt(30)
  v_smfmac_f32_16x16x32_bf16 v[28:31], v[26:27], v[60:63], v198
  v_and_b32_dpp v26, v7, v200 row_newbcast:0 row_mask:0xf bank_mask:0x1
  v_and_b32_dpp v27, v7, v200 row_newbcast:0 row_mask:0xf bank_mask:0x2
  v_and_b32_dpp v26, v7, v200 row_newbcast:8 row_mask:0xf bank_mask:0x4
  v_and_b32_dpp v27, v7, v200 row_newbcast:8 row_mask:0xf bank_mask:0x8
  s_waitcnt vmcnt(29)
  v_smfmac_f32_16x16x32_bf16 v[28:31], v[24:25], v[64:67], v198
  v_and_b32_dpp v24, v4, v200 row_newbcast:1 row_mask:0xf bank_mask:0x1
  v_and_b32_dpp v25, v4, v200 row_newbcast:1 row_mask:0xf bank_mask:0x2
  v_and_b32_dpp v24, v4, v200 row_newbcast:9 row_mask:0xf bank_mask:0x4
  v_and_b32_dpp v25, v4, v200 row_newbcast:9 row_mask:0xf bank_mask:0x8
  s_waitcnt vmcnt(28)
  v_smfmac_f32_16x16x32_bf16 v[28:31], v[26:27], v[68:71], v198
  v_and_b32_dpp v26, v5, v200 row_newbcast:1 row_mask:0xf bank_mask:0x1
  v_and_b32_dpp v27, v5, v200 row_newbcast:1 row_mask:0xf bank_mask:0x2
  v_and_b32_dpp v26, v5, v200 row_newbcast:9 row_mask:0xf bank_mask:0x4
  v_and_b32_dpp v27, v5, v200 row_newbcast:9 row_mask:0xf bank_mask:0x8
  s_waitcnt vmcnt(27)
  v_smfmac_f32_16x16x32_bf16 v[28:31], v[24:25], v[72:75], v198
  v_and_b32_dpp v24, v6, v200 row_newbcast:1 row_mask:0xf bank_mask:0x1
  v_and_b32_dpp v25, v6, v200 row_newbcast:1 row_mask:0xf bank_mask:0x2
  v_and_b32_dpp v24, v6, v200 row_newbcast:9 row_mask:0xf bank_mask:0x4
  v_and_b32_dpp v25, v6, v200 row_newbcast:9 row_mask:0xf bank_mask:0x8
  s_waitcnt vmcnt(26)
  v_smfmac_f32_16x16x32_bf16 v[28:31], v[26:27], v[76:79], v198
  v_and_b32_dpp v26, v7, v200 row_newbcast:1 row_mask:0xf bank_mask:0x1
  v_and_b32_dpp v27, v7, v200 row_newbcast:1 row_mask:0xf bank_mask:0x2
  v_and_b32_dpp v26, v7, v200 row_newbcast:9 row_mask:0xf bank_mask:0x4
  v_and_b32_dpp v27, v7, v200 row_newbcast:9 row_mask:0xf bank_mask:0x8
  s_waitcnt vmcnt(25)
  v_smfmac_f32_16x16x32_bf16 v[28:31], v[24:25], v[80:83], v198
  v_and_b32_dpp v24, v4, v200 row_newbcast:2 row_mask:0xf bank_mask:0x1
  v_and_b32_dpp v25, v4, v200 row_newbcast:2 row_mask:0xf bank_mask:0x2
  v_and_b32_dpp v24, v4, v200 row_newbcast:10 row_mask:0xf bank_mask:0x4
  v_and_b32_dpp v25, v4, v200 row_newbcast:10 row_mask:0xf bank_mask:0x8
  s_waitcnt vmcnt(24)
  v_smfmac_f32_16x16x32_bf16 v[28:31], v[26:27], v[84:87], v198
  v_and_b32_dpp v26, v5, v200 row_newbcast:2 row_mask:0xf bank_mask:0x1
  v_and_b32_dpp v27, v5, v200 row_newbcast:2 row_mask:0xf bank_mask:0x2
  v_and_b32_dpp v26, v5, v200 row_newbcast:10 row_mask:0xf bank_mask:0x4
  v_and_b32_dpp v27, v5, v200 row_newbcast:10 row_mask:0xf bank_mask:0x8
  s_waitcnt vmcnt(23)
  v_smfmac_f32_16x16x32_bf16 v[28:31], v[24:25], v[88:91], v198
  v_and_b32_dpp v24, v6, v200 row_newbcast:2 row_mask:0xf bank_mask:0x1
  v_and_b32_dpp v25, v6, v200 row_newbcast:2 row_mask:0xf bank_mask:0x2
  v_and_b32_dpp v24, v6, v200 row_newbcast:10 row_mask:0xf bank_mask:0x4
  v_and_b32_dpp v25, v6, v200 row_newbcast:10 row_mask:0xf bank_mask:0x8
  s_waitcnt vmcnt(22)
  v_smfmac_f32_16x16x32_bf16 v[28:31], v[26:27], v[92:95], v198
  v_and_b32_dpp v26, v7, v200 row_newbcast:2 row_mask:0xf bank_mask:0x1
  v_and_b32_dpp v27, v7, v200 row_newbcast:2 row_mask:0xf bank_mask:0x2
  v_and_b32_dpp v26, v7, v200 row_newbcast:10 row_mask:0xf bank_mask:0x4
  v_and_b32_dpp v27, v7, v200 row_newbcast:10 row_mask:0xf bank_mask:0x8
  s_waitcnt vmcnt(21)
  v_smfmac_f32_16x16x32_bf16 v[28:31], v[24:25], v[96:99], v198
  v_and_b32_dpp v24, v4, v200 row_newbcast:3 row_mask:0xf bank_mask:0x1
  v_and_b32_dpp v25, v4, v200 row_newbcast:3 row_mask:0xf bank_mask:0x2
  v_and_b32_dpp v24, v4, v200 row_newbcast:11 row_mask:0xf bank_mask:0x4
  v_and_b32_dpp v25, v4, v200 row_newbcast:11 row_mask:0xf bank_mask:0x8
  s_waitcnt vmcnt(20)
  v_smfmac_f32_16x16x32_bf16 v[28:31], v[26:27], v[100:103], v198
  v_and_b32_dpp v26, v5, v200 row_newbcast:3 row_mask:0xf bank_mask:0x1
  v_and_b32_dpp v27, v5, v200 row_newbcast:3 row_mask:0xf bank_mask:0x2
  v_and_b32_dpp v26, v5, v200 row_newbcast:11 row_mask:0xf bank_mask:0x4
  v_and_b32_dpp v27, v5, v200 row_newbcast:11 row_mask:0xf bank_mask:0x8
  s_waitcnt vmcnt(19)
  v_smfmac_f32_16x16x32_bf16 v[28:31], v[24:25], v[104:107], v198
  v_and_b32_dpp v24, v6, v200 row_newbcast:3 row_mask:0xf bank_mask:0x1
  v_and_b32_dpp v25, v6, v200 row_newbcast:3 row_mask:0xf bank_mask:0x2
  v_and_b32_dpp v24, v6, v200 row_newbcast:11 row_mask:0xf bank_mask:0x4
  v_and_b32_dpp v25, v6, v200 row_newbcast:11 row_mask:0xf bank_mask:0x8
  s_waitcnt vmcnt(18)
  v_smfmac_f32_16x16x32_bf16 v[28:31], v[26:27], v[108:111], v198
  v_and_b32_dpp v26, v7, v200 row_newbcast:3 row_mask:0xf bank_mask:0x1
  v_and_b32_dpp v27, v7, v200 row_newbcast:3 row_mask:0xf bank_mask:0x2
  v_and_b32_dpp v26, v7, v200 row_newbcast:11 row_mask:0xf bank_mask:0x4
  v_and_b32_dpp v27, v7, v200 row_newbcast:11 row_mask:0xf bank_mask:0x8
  s_waitcnt vmcnt(17)
  v_smfmac_f32_16x16x32_bf16 v[28:31], v[24:25], v[112:115], v198
  v_and_b32_dpp v24, v4, v200 row_newbcast:4 row_mask:0xf bank_mask:0x1
  v_and_b32_dpp v25, v4, v200 row_newbcast:4 row_mask:0xf bank_mask:0x2
  v_and_b32_dpp v24, v4, v200 row_newbcast:12 row_mask:0xf bank_mask:0x4
  v_and_b32_dpp v25, v4, v200 row_newbcast:12 row_mask:0xf bank_mask:0x8
  s_waitcnt vmcnt(16)
  v_smfmac_f32_16x16x32_bf16 v[28:31], v[26:27], v[116:119], v198
  v_and_b32_dpp v26, v5, v200 row_newbcast:4 row_mask:0xf bank_mask:0x1
  v_and_b32_dpp v27, v5, v200 row_newbcast:4 row_mask:0xf bank_mask:0x2
  v_and_b32_dpp v26, v5, v200 row_newbcast:12 row_mask:0xf bank_mask:0x4
  v_and_b32_dpp v27, v5, v200 row_newbcast:12 row_mask:0xf bank_mask:0x8
  s_waitcnt vmcnt(15)
  v_smfmac_f32_16x16x32_bf16 v[28:31], v[24:25], v[120:123], v198
  v_and_b32_dpp v24, v6, v200 row_newbcast:4 row_mask:0xf bank_mask:0x1
  v_and_b32_dpp v25, v6, v200 row_newbcast:4 row_mask:0xf bank_mask:0x2
  v_and_b32_dpp v24, v6, v200 row_newbcast:12 row_mask:0xf bank_mask:0x4
  v_and_b32_dpp v25, v6, v200 row_newbcast:12 row_mask:0xf bank_mask:0x8
  s_waitcnt vmcnt(14)
  v_smfmac_f32_16x16x32_bf16 v[28:31], v[26:27], v[124:127], v198
  v_and_b32_dpp v26, v7, v200 row_newbcast:4 row_mask:0xf bank_mask:0x1
  v_and_b32_dpp v27, v7, v200 row_newbcast:4 row_mask:0xf bank_mask:0x2
  v_and_b32_dpp v26, v7, v200 row_newbcast:12 row_mask:0xf bank_mask:0x4
  v_and_b32_dpp v27, v7, v200 row_newbcast:12 row_mask:0xf bank_mask:0x8
  s_waitcnt vmcnt(13)
  v_smfmac_f32_16x16x32_bf16 v[28:31], v[24:25], v[128:131], v198
  v_and_b32_dpp v24, v4, v200 row_newbcast:5 row_mask:0xf bank_mask:0x1
  v_and_b32_dpp v25, v4, v200 row_newbcast:5 row_mask:0xf bank_mask:0x2
  v_and_b32_dpp v24, v4, v200 row_newbcast:13 row_mask:0xf bank_mask:0x4
  v_and_b32_dpp v25, v4, v200 row_newbcast:13 row_mask:0xf bank_mask:0x8
  s_waitcnt vmcnt(12)
  v_smfmac_f32_16x16x32_bf16 v[28:31], v[26:27], v[132:135], v198
  v_and_b32_dpp v26, v5, v200 row_newbcast:5 row_mask:0xf bank_mask:0x1
  v_and_b32_dpp v27, v5, v200 row_newbcast:5 row_mask:0xf bank_mask:0x2
  v_and_b32_dpp v26, v5, v200 row_newbcast:13 row_mask:0xf bank_mask:0x4
  v_and_b32_dpp v27, v5, v200 row_newbcast:13 row_mask:0xf bank_mask:0x8
  s_waitcnt vmcnt(11)
  v_smfmac_f32_16x16x32_bf16 v[28:31], v[24:25], v[136:139], v198
  v_and_b32_dpp v24, v6, v200 row_newbcast:5 row_mask:0xf bank_mask:0x1
  v_and_b32_dpp v25, v6, v200 row_newbcast:5 row_mask:0xf bank_mask:0x2
  v_and_b32_dpp v24, v6, v200 row_newbcast:13 row_mask:0xf bank_mask:0x4
  v_and_b32_dpp v25, v6, v200 row_newbcast:13 row_mask:0xf bank_mask:0x8
  s_waitcnt vmcnt(10)
  v_smfmac_f32_16x16x32_bf16 v[28:31], v[26:27], v[140:143], v198
  v_and_b32_dpp v26, v7, v200 row_newbcast:5 row_mask:0xf bank_mask:0x1
  v_and_b32_dpp v27, v7, v200 row_newbcast:5 row_mask:0xf bank_mask:0x2
  v_and_b32_dpp v26, v7, v200 row_newbcast:13 row_mask:0xf bank_mask:0x4
  v_and_b32_dpp v27, v7, v200 row_newbcast:13 row_mask:0xf bank_mask:0x8
  s_waitcnt vmcnt(9)
  v_smfmac_f32_16x16x32_bf16 v[28:31], v[24:25], v[144:147], v198
  v_and_b32_dpp v24, v4, v200 row_newbcast:6 row_mask:0xf bank_mask:0x1
  v_and_b32_dpp v25, v4, v200 row_newbcast:6 row_mask:0xf bank_mask:0x2
  v_and_b32_dpp v24, v4, v200 row_newbcast:14 row_mask:0xf bank_mask:0x4
  v_and_b32_dpp v25, v4, v200 row_newbcast:14 row_mask:0xf bank_mask:0x8
  s_waitcnt vmcnt(8)
  v_smfmac_f32_16x16x32_bf16 v[28:31], v[26:27], v[148:151], v198
  v_and_b32_dpp v26, v5, v200 row_newbcast:6 row_mask:0xf bank_mask:0x1
  v_and_b32_dpp v27, v5, v200 row_newbcast:6 row_mask:0xf bank_mask:0x2
  v_and_b32_dpp v26, v5, v200 row_newbcast:14 row_mask:0xf bank_mask:0x4
  v_and_b32_dpp v27, v5, v200 row_newbcast:14 row_mask:0xf bank_mask:0x8
  s_waitcnt vmcnt(7)
  v_smfmac_f32_16x16x32_bf16 v[28:31], v[24:25], v[152:155], v198
  v_and_b32_dpp v24, v6, v200 row_newbcast:6 row_mask:0xf bank_mask:0x1
  v_and_b32_dpp v25, v6, v200 row_newbcast:6 row_mask:0xf bank_mask:0x2
  v_and_b32_dpp v24, v6, v200 row_newbcast:14 row_mask:0xf bank_mask:0x4
  v_and_b32_dpp v25, v6, v200 row_newbcast:14 row_mask:0xf bank_mask:0x8
  s_waitcnt vmcnt(6)
  v_smfmac_f32_16x16x32_bf16 v[28:31], v[26:27], v[156:159], v198
  v_and_b32_dpp v26, v7, v200 row_newbcast:6 row_mask:0xf bank_mask:0x1
  v_and_b32_dpp v27, v7, v200 row_newbcast:6 row_mask:0xf bank_mask:0x2
  v_and_b32_dpp v26, v7, v200 row_newbcast:14 row_mask:0xf bank_mask:0x4
  v_and_b32_dpp v27, v7, v200 row_newbcast:14 row_mask:0xf bank_mask:0x8
  s_waitcnt vmcnt(5)
  v_smfmac_f32_16x16x32_bf16 v[28:31], v[24:25], v[160:163], v198
  v_and_b32_dpp v24, v4, v200 row_newbcast:7 row_mask:0xf bank_mask:0x1
  v_and_b32_dpp v25, v4, v200 row_newbcast:7 row_mask:0xf bank_mask:0x2
  v_and_b32_dpp v24, v4, v200 row_newbcast:15 row_mask:0xf bank_mask:0x4
  v_and_b32_dpp v25, v4, v200 row_newbcast:15 row_mask:0xf bank_mask:0x8
  s_waitcnt vmcnt(4)
  v_smfmac_f32_16x16x32_bf16 v[28:31], v[26:27], v[164:167], v198
  v_and_b32_dpp v26, v5, v200 row_newbcast:7 row_mask:0xf bank_mask:0x1
  v_and_b32_dpp v27, v5, v200 row_newbcast:7 row_mask:0xf bank_mask:0x2
  v_and_b32_dpp v26, v5, v200 row_newbcast:15 row_mask:0xf bank_mask:0x4
  v_and_b32_dpp v27, v5, v200 row_newbcast:15 row_mask:0xf bank_mask:0x8
  s_waitcnt vmcnt(3)
  v_smfmac_f32_16x16x32_bf16 v[28:31], v[24:25], v[168:171], v198
  v_and_b32_dpp v24, v6, v200 row_newbcast:7 row_mask:0xf bank_mask:0x1
  v_and_b32_dpp v25, v6, v200 row_newbcast:7 row_mask:0xf bank_mask:0x2
  v_and_b32_dpp v24, v6, v200 row_newbcast:15 row_mask:0xf bank_mask:0x4
  v_and_b32_dpp v25, v6, v200 row_newbcast:15 row_mask:0xf bank_mask:0x8
  s_waitcnt vmcnt(2)
  v_smfmac_f32_16x16x32_bf16 v[28:31], v[26:27], v[172:175], v198
  v_and_b32_dpp v26, v7, v200 row_newbcast:7 row_mask:0xf bank_mask:0x1
  v_and_b32_dpp v27, v7, v200 row_newbcast:7 row_mask:0xf bank_mask:0x2
  v_and_b32_dpp v26, v7, v200 row_newbcast:15 row_mask:0xf bank_mask:0x4
  v_and_b32_dpp v27, v7, v200 row_newbcast:15 row_mask:0xf bank_mask:0x8
  s_waitcnt vmcnt(1)
  v_smfmac_f32_16x16x32_bf16 v[28:31], v[24:25], v[176:179], v198
  s_nop 1
  s_waitcnt vmcnt(0)
  v_smfmac_f32_16x16x32_bf16 v[28:31], v[26:27], v[180:183], v198
  s_nop 11
  v_mov_b32_dpp v32, v28 row_ror:8 row_mask:0xf bank_mask:0xf
  v_mov_b32_dpp v33, v29 row_ror:8 row_mask:0xf bank_mask:0xf
  v_mov_b32_dpp v34, v30 row_ror:8 row_mask:0xf bank_mask:0xf
  v_mov_b32_dpp v35, v31 row_ror:8 row_mask:0xf bank_mask:0xf
  s_nop 0
  v_permlane32_swap_b32 v32, v40
  v_permlane32_swap_b32 v33, v41
  v_permlane32_swap_b32 v34, v42
  v_permlane32_swap_b32 v35, v43
  v_add_f32 v28, v28, v40
  v_add_f32 v29, v29, v41
  v_add_f32 v30, v30, v42
  v_add_f32 v31, v31, v43
  v_bfi_b32 v28, v193, v192, v28
  v_bfi_b32 v29, v193, v192, v29
  v_bfi_b32 v30, v193, v192, v30
  v_bfi_b32 v31, v193, v192, v31
  s_mov_b64 exec, 0x00ff00ff
  buffer_store_dwordx4 v[28:31], v201, s[20:23], s65 offen sc1
  s_mov_b64 exec, -1
  s_getreg_b32 s78, hwreg(HW_REG_XCC_ID)
  s_and_b32 s78, s78, 15
  s_lshl_b32 s74, s5, 8
  s_add_u32 s74, s74, 16384
  s_cmp_lg_u32 s4, 0
  s_cbranch_scc1 L_noxr
  v_mov_b32 v32, s78
  v_mov_b32 v33, v192
  v_mov_b32 v34, s78
  v_mov_b32 v35, v192
  s_mov_b64 exec, 15
  buffer_store_dwordx4 v[32:35], v1, s[20:23], s74 offen sc1
  s_mov_b64 exec, -1
L_noxr:
  s_mov_b32 s63, 524288
L_pollQ:
  buffer_load_dwordx4 v[56:59], v1, s[20:23], s69 offen offset:0 sc1
  buffer_load_dwordx4 v[60:63], v1, s[20:23], s69 offen offset:1024 sc1
  s_sub_u32 s63, s63, 1
  s_waitcnt vmcnt(0)
  s_cbranch_scc1 L_pollokQ
  v_bitop3_b32 v40, v56, v57, v192 bitop3:0x7e
  v_bitop3_b32 v42, v58, v59, v192 bitop3:0x7e
  v_or_b32 v40, v40, v42
  v_bitop3_b32 v41, v60, v61, v192 bitop3:0x7e
  v_bitop3_b32 v42, v62, v63, v192 bitop3:0x7e
  v_or3_b32 v40, v40, v41, v42
  v_and_b32 v40, v193, v40
  v_cmp_ne_u32 vcc, 0, v40
  s_cbranch_vccz L_pollokQ
  s_sleep 1
  s_branch L_pollQ
L_pollokQ:
  v_bfi_b32 v56, v193, v199, v56
  v_bfi_b32 v57, v193, v199, v57
  v_bfi_b32 v58, v193, v199, v58
  v_bfi_b32 v59, v193, v199, v59
  v_bfi_b32 v60, v193, v199, v60
  v_bfi_b32 v61, v193, v199, v61
  v_bfi_b32 v62, v193, v199, v62
  v_bfi_b32 v63, v193, v199, v63
  v_add_f32 v56, v56, v60
  v_add_f32 v57, v57, v61
  v_add_f32 v58, v58, v62
  v_add_f32 v59, v59, v63
  v_and_b32 v18, 31, v0
  v_lshrrev_b32 v19, 5, v0
  s_nop 1
  v_permlane32_swap_b32 v56, v58
  v_permlane32_swap_b32 v57, v59
  v_lshlrev_b32 v20, 3, v18
  v_lshl_add_u32 v20, v19, 2, v20
  v_add_f32 v56, v56, v58
  v_add_f32 v57, v57, v59
  v_cvt_pk_bf16_f32 v17, v56, v57
  ds_write_b32 v20, v17 offset:0
  s_waitcnt lgkmcnt(0)
  s_barrier
  v_lshlrev_b32 v52, 4, v18
  v_mul_u32_u24 v53, 640, v19
  v_add_u32 v53, v53, v52
  v_lshl_add_u32 v3, v19, 3, v52
  s_cmp_ge_u32 s71, 28
  s_cbranch_scc1 L_hnoffn
  v_and_b32 v17, 15, v0
  v_lshlrev_b32 v17, 4, v17
  v_bfe_u32 v20, v0, 4, 1
  v_lshl_add_u32 v21, v20, 9, v17
  v_lshl_add_u32 v17, v20, 10, v17
  ds_read_b128 v[56:59], v17 offset:512
  ds_read_b128 v[60:63], v17 offset:768
  ds_read_b128 v[64:67], v17 offset:1024
  ds_read_b128 v[68:71], v17 offset:1280
  s_lshl_b32 s69, s71, 12
  s_add_u32 s69, s69, 196608
  s_lshr_b32 s65, s77, 1
  s_lshl_b32 s65, s65, 10
  s_add_u32 s65, s65, s69
  s_and_b32 s66, s77, 1
  s_lshl_b32 s66, s66, 8
  s_add_u32 s65, s65, s66
  s_waitcnt lgkmcnt(0)
  v_add_f32 v56, v56, v60
  v_add_f32 v64, v64, v68
  v_add_f32 v57, v57, v61
  v_add_f32 v65, v65, v69
  v_add_f32 v58, v58, v62
  v_add_f32 v66, v66, v70
  v_add_f32 v59, v59, v63
  v_add_f32 v67, v67, v71
  v_add_f32 v28, v56, v64
  v_add_f32 v29, v57, v65
  v_add_f32 v30, v58, v66
  v_add_f32 v31, v59, v67
  v_bfi_b32 v28, v193, v192, v28
  v_bfi_b32 v29, v193, v192, v29
  v_bfi_b32 v30, v193, v192, v30
  v_bfi_b32 v31, v193, v192, v31
  s_mov_b32 exec_hi, 0
  buffer_store_dwordx4 v[28:31], v21, s[20:23], s65 offen sc1 nt
  s_mov_b32 exec_hi, -1
  s_and_b32 s66, s71, 7
  s_cmp_lg_u32 s66, s77
  s_cbranch_scc1 L_hnoffn
  s_mov_b32 s63, 8388608
L_lwG:
  s_sleep 8
  ds_read_b32 v17, v54 offset:4684
  s_sub_u32 s63, s63, 1
  s_waitcnt lgkmcnt(0)
  s_cbranch_scc1 L_lwokG
  v_cmp_eq_u32 vcc, 0, v17
  s_cbranch_vccnz L_lwG
L_lwokG:
  s_mov_b32 s63, 524288
L_pollG:
  buffer_load_dwordx4 v[56:59], v1, s[20:23], s69 offen offset:0 sc1 nt
  buffer_load_dwordx4 v[60:63], v1, s[20:23], s69 offen offset:1024 sc1 nt
  buffer_load_dwordx4 v[64:67], v1, s[20:23], s69 offen offset:2048 sc1 nt
  buffer_load_dwordx4 v[68:71], v1, s[20:23], s69 offen offset:3072 sc1 nt
  s_sub_u32 s63, s63, 1
  s_waitcnt vmcnt(0)
  s_cbranch_scc1 L_pollokG
  v_bitop3_b32 v40, v56, v57, v192 bitop3:0x7e
  v_bitop3_b32 v42, v58, v59, v192 bitop3:0x7e
  v_or_b32 v40, v40, v42
  v_bitop3_b32 v41, v60, v61, v192 bitop3:0x7e
  v_bitop3_b32 v42, v62, v63, v192 bitop3:0x7e
  v_or3_b32 v40, v40, v41, v42
  v_bitop3_b32 v41, v64, v65, v192 bitop3:0x7e
  v_bitop3_b32 v42, v66, v67, v192 bitop3:0x7e
  v_or3_b32 v40, v40, v41, v42
  v_bitop3_b32 v41, v68, v69, v192 bitop3:0x7e
  v_bitop3_b32 v42, v70, v71, v192 bitop3:0x7e
  v_or3_b32 v40, v40, v41, v42
  v_and_b32 v40, v193, v40
  v_cmp_ne_u32 vcc, 0, v40
  s_cbranch_vccz L_pollokG
  s_sleep 8
  s_branch L_pollG
L_pollokG:
  v_bfi_b32 v56, v193, v199, v56
  v_bfi_b32 v57, v193, v199, v57
  v_bfi_b32 v58, v193, v199, v58
  v_bfi_b32 v59, v193, v199, v59
  v_bfi_b32 v60, v193, v199, v60
  v_bfi_b32 v61, v193, v199, v61
  v_bfi_b32 v62, v193, v199, v62
  v_bfi_b32 v63, v193, v199, v63
  v_bfi_b32 v64, v193, v199, v64
  v_bfi_b32 v65, v193, v199, v65
  v_bfi_b32 v66, v193, v199, v66
  v_bfi_b32 v67, v193, v199, v67
  v_bfi_b32 v68, v193, v199, v68
  v_bfi_b32 v69, v193, v199, v69
  v_bfi_b32 v70, v193, v199, v70
  v_bfi_b32 v71, v193, v199, v71
  v_add_f32 v56, v56, v60
  v_add_f32 v57, v57, v61
  v_add_f32 v58, v58, v62
  v_add_f32 v59, v59, v63
  v_add_f32 v56, v56, v64
  v_add_f32 v57, v57, v65
  v_add_f32 v58, v58, v66
  v_add_f32 v59, v59, v67
  v_add_f32 v56, v56, v68
  v_add_f32 v57, v57, v69
  v_add_f32 v58, v58, v70
  v_add_f32 v59, v59, v71
  s_nop 1
  v_permlane32_swap_b32 v56, v58
  v_permlane32_swap_b32 v57, v59
  v_cvt_pk_bf16_f32 v56, v56, v56
  v_and_b32 v56, s76, v56
  v_cvt_pk_bf16_f32 v58, v58, v58
  v_and_b32 v58, s76, v58
  v_mul_f32 v17, v56, v56
  v_mul_f32 v17, 0x3d372713, v17
  v_fma_f32 v17, v17, v56, v56
  v_mul_f32 v17, 0xc0135761, v17
  v_exp_f32 v17, v17
  s_nop 0
  v_add_f32 v17, 1.0, v17
  v_rcp_f32 v17, v17
  s_nop 0
  v_mul_f32 v17, v17, v56
  v_cvt_pk_bf16_f32 v17, v17, v17
  v_and_b32 v17, s76, v17
  v_mul_f32 v17, v17, v58
  v_cvt_pk_bf16_f32 v50, v17, v17
  v_cvt_pk_bf16_f32 v57, v57, v57
  v_and_b32 v57, s76, v57
  v_cvt_pk_bf16_f32 v59, v59, v59
  v_and_b32 v59, s76, v59
  v_mul_f32 v19, v57, v57
  v_mul_f32 v19, 0x3d372713, v19
  v_fma_f32 v19, v19, v57, v57
  v_mul_f32 v19, 0xc0135761, v19
  v_exp_f32 v19, v19
  s_nop 0
  v_add_f32 v19, 1.0, v19
  v_rcp_f32 v19, v19
  s_nop 0
  v_mul_f32 v19, v19, v57
  v_cvt_pk_bf16_f32 v19, v19, v19
  v_and_b32 v19, s76, v19
  v_mul_f32 v19, v19, v59
  v_cvt_pk_bf16_f32 v51, v19, v19
  v_bfi_b32 v50, s76, v51, v50
  v_mov_b32 v51, v192
  s_lshl_b32 s65, s71, 9
  s_add_u32 s65, s65, 393216
  buffer_store_dwordx2 v[50:51], v3, s[20:23], s65 offen sc1
L_hnoffn:
  s_mov_b32 s63, 8388608
L_lwX:
  s_sleep 8
  ds_read_b32 v17, v54 offset:4700
  s_sub_u32 s63, s63, 1
  s_waitcnt lgkmcnt(0)
  s_cbranch_scc1 L_lwokX
  v_cmp_eq_u32 vcc, 0, v17
  s_cbranch_vccnz L_lwX
L_lwokX:
  s_mov_b32 s63, 524288
L_pollX:
  buffer_load_dwordx2 v[56:57], v54, s[20:23], s74 offen sc1
  s_sub_u32 s63, s63, 1
  s_waitcnt vmcnt(0)
  s_cbranch_scc1 L_pollokX
  v_bitop3_b32 v40, v57, v57, v192 bitop3:0x7e
  v_cmp_ne_u32 vcc, 0, v40
  s_cbranch_vccz L_pollokX
  s_sleep 8
  s_branch L_pollX
L_pollokX:
  v_readfirstlane_b32 s65, v56
  s_cmp_eq_u32 s65, s78
  s_cselect_b32 s78, 0, 0x100
  v_mov_b32 v56, s78
  ds_write_b32 v54, v56 offset:296
  s_cmp_ge_u32 s71, 28
  s_cbranch_scc1 L_noh
  s_lshl_b32 s65, s71, 9
  s_add_u32 s69, s65, 393216
  s_mov_b32 s63, 524288
L_pollH:
  buffer_load_dwordx2 v[56:57], v3, s[20:23], s69 offen sc1
  s_sub_u32 s63, s63, 1
  s_waitcnt vmcnt(0)
  s_cbranch_scc1 L_pollokH
  v_bitop3_b32 v40, v57, v57, v192 bitop3:0x7e
  v_cmp_ne_u32 vcc, 0, v40
  s_cbranch_vccz L_pollokH
  s_sleep 8
  s_branch L_pollH
L_pollokH:
  v_and_b32 v50, 0xffff, v56
  v_lshrrev_b32 v51, 16, v56
  v_lshl_or_b32 v50, v50, 16, v50
  v_lshl_or_b32 v51, v51, 16, v51
  ds_write_b64 v3, v[50:51] offset:3648
  ds_write_b32 v54, v194 offset:280
L_noh:
  s_mov_b32 s62, 18
  s_mov_b32 s6, 32768
  v_mov_b32 v17, 40
  v_mov_b32 v22, v192
  v_and_b32 v18, 63, v0
  v_lshlrev_b32 v18, 8, v18
  s_and_b32 s65, s79, 7
  s_lshr_b32 s66, s79, 3
  s_lshr_b32 s7, s66, 2
  s_lshl_b32 s7, s7, 3
  s_add_u32 s7, s7, s65
  s_lshl_b32 s7, s7, 8
  s_mul_i32 s70, s65, 5
  s_xor_b32 s70, s70, s66
  s_and_b32 s70, s70, 3
  s_cmp_lg_u32 s70, 0
  s_cbranch_scc1 L_cal
  s_add_u32 s66, s6, s7
  v_lshlrev_b32 v19, 14, v0
  s_mov_b64 exec, 3
  buffer_load_dword v23, v19, s[20:23], s66 offen
  s_mov_b64 exec, -1
L_cal:
  s_mov_b32 s63, 8388608
L_lwC:
  s_sleep 8
  ds_read_b32 v58, v17 offset:4704
  ds_read_b32 v59, v17 offset:5344
  s_sub_u32 s63, s63, 1
  s_waitcnt lgkmcnt(0)
  s_cbranch_scc1 L_lwokC
  v_min_u32 v40, v58, v59
  v_cmp_eq_u32 vcc, 0, v40
  s_cbranch_vccnz L_lwC
L_lwokC:
  ds_read_b32 v56, v17 offset:4672
  ds_read_b32 v57, v17 offset:5312
  v_add_u32 v29, v58, v59
  v_mov_b32 v30, v22
  v_mov_b32 v31, v22
  s_waitcnt lgkmcnt(0)
  v_add_u32 v28, v56, v57
  s_cmp_lg_u32 s70, 0
  s_cbranch_scc1 L_cnp
  s_add_u32 s66, s6, s7
  s_mov_b64 exec, 15
  buffer_store_dwordx4 v[28:31], v1, s[20:23], s66 offen sc1
  s_mov_b64 exec, -1
L_cnp:
  s_mov_b32 s63, 8388608
L_lwD:
  s_sleep 8
  ds_read_b32 v58, v17 offset:4716
  s_sub_u32 s63, s63, 1
  s_waitcnt lgkmcnt(0)
  s_cbranch_scc1 L_lwokD
  v_cmp_eq_u32 vcc, 0, v58
  s_cbranch_vccnz L_lwD
L_lwokD:
  s_mov_b32 s63, 512
L_pollC:
  buffer_load_dwordx4 v[56:59], v18, s[20:23], s6 offen sc1
  s_sub_u32 s63, s63, 1
  s_waitcnt vmcnt(0)
  s_cbranch_scc1 L_pollokC
  v_bitop3_b32 v40, v59, v59, v22 bitop3:0x7e
  v_cmp_ne_u32 vcc, 0, v40
  s_cbranch_vccz L_pollokC
  s_sleep 16
  s_branch L_pollC
L_pollokC:
  v_sub_u32 v56, v57, v56
  v_sub_u32 v58, v57, v29
  s_nop 1
  v_add_u32_dpp v56, v56, v56 quad_perm:[1,0,3,2] row_mask:0xf bank_mask:0xf
  s_nop 1
  v_add_u32_dpp v56, v56, v56 quad_perm:[2,3,0,1] row_mask:0xf bank_mask:0xf
  s_nop 1
  v_add_u32_dpp v56, v56, v56 row_half_mirror row_mask:0xf bank_mask:0xf
  s_nop 1
  v_add_u32_dpp v56, v56, v56 row_mirror row_mask:0xf bank_mask:0xf
  s_nop 0
  v_readlane_b32 s65, v56, 0
  v_readlane_b32 s66, v56, 16
  v_readlane_b32 s67, v56, 32
  v_readlane_b32 s68, v56, 48
  s_nop 0
  v_mov_b32 v56, s65
  v_add_u32 v56, s66, v56
  v_add_u32 v56, s67, v56
  v_add_u32 v56, s68, v56
  s_nop 1
  v_add_u32_dpp v58, v58, v58 quad_perm:[1,0,3,2] row_mask:0xf bank_mask:0xf
  s_nop 1
  v_add_u32_dpp v58, v58, v58 quad_perm:[2,3,0,1] row_mask:0xf bank_mask:0xf
  s_nop 1
  v_add_u32_dpp v58, v58, v58 row_half_mirror row_mask:0xf bank_mask:0xf
  s_nop 1
  v_add_u32_dpp v58, v58, v58 row_mirror row_mask:0xf bank_mask:0xf
  s_nop 0
  v_readlane_b32 s65, v58, 0
  v_readlane_b32 s66, v58, 16
  v_readlane_b32 s67, v58, 32
  v_readlane_b32 s68, v58, 48
  s_nop 0
  v_mov_b32 v58, s65
  v_add_u32 v58, s66, v58
  v_add_u32 v58, s67, v58
  v_add_u32 v58, s68, v58
  v_lshrrev_b32 v57, 6, v56
  v_ashrrev_i32 v58, 3, v58
  v_lshl_add_u32 v56, v29, 3, v58
  s_cmp_eq_u32 s62, 18
  s_cbranch_scc1 L_first
  v_sub_u32 v57, v56, v32
  v_lshrrev_b32 v57, 4, v57
  v_add_u32 v33, 6, v33
  v_min_u32 v57, v57, v33
L_first:
  v_mov_b32 v32, v56
  v_mov_b32 v33, v57
  v_mul_u32_u24 v58, s62, v57
  v_sub_u32 v56, v56, v58
  v_add_u32 v56, 448, v56
  ds_write_b64 v54, v[56:57] offset:264
  v_add_u32 v17, 64, v17
  v_add_u32 v22, 0x10000, v22
  s_add_u32 s62, s62, 16
  s_xor_b32 s6, s6, 0x4000
  s_cmp_le_u32 s62, 114
  s_cbranch_scc1 L_cal
  s_lshl_b32 s65, s5, 8
  s_lshl_b32 s66, s4, 3
  s_add_u32 s64, s65, s66
  buffer_load_dwordx2 v[36:37], v54, s[16:19], s64 offen
  v_lshlrev_b32 v17, 7, v0
  v_add_u32 v18, L_last-L_pc, v17
  v_min_u32 v18, L_codeend-L_pc-4, v18
  v_add_u32 v17, L_tail-L_pc, v17
  v_min_u32 v17, L_stream-L_pc, v17
  global_load_dword v23, v17, s[32:33]
  global_load_dword v23, v18, s[32:33]
  s_mov_b32 s28, s54
  s_mov_b32 s29, s55
  s_mov_b32 s30, 2048
  s_mov_b32 s31, 0x20000
  s_mul_i32 s69, s2, 640
  s_add_u32 s69, s69, 458752
  s_mul_i32 s62, s4, 5120
  s_add_u32 s62, s62, 458752
  s_lshl_b32 s7, s5, 15
  s_lshl_b32 s66, s4, 4
  s_add_u32 s7, s7, s66
  s_add_u32 s7, s7, 786432
  v_and_b32 v20, 7, v0
  v_lshrrev_b32 v19, 5, v0
  v_xor_b32 v20, v20, v19
  v_mul_u32_u24 v20, 640, v20
  v_lshrrev_b32 v19, 3, v0
  v_lshl_add_u32 v38, v19, 3, v20
  v_lshlrev_b32 v39, 9, v0
  s_mov_b32 s72, 0
  s_mov_b32 s73, -1
  v_mov_b32 v76, 0
  v_mov_b32 v77, 0
  v_mov_b32 v78, 0
  v_mov_b32 v79, 0
L_tail:
  s_mov_b32 s63, 8388608
L_lwM:
  s_sleep 1
  ds_read_b32 v20, v54 offset:304
  ds_read_b32 v21, v54 offset:308
  ds_read_b128 v[40:43], v54 offset:3584
  ds_read_b32 v18, v54 offset:3600
  ds_read_b128 v[44:47], v54 offset:3616
  ds_read_b32 v19, v54 offset:3632
  s_sub_u32 s63, s63, 1
  s_waitcnt lgkmcnt(0)
  s_cbranch_scc1 L_lwokM
  v_min_u32 v20, v20, v21
  v_cmp_eq_u32 vcc, 0, v20
  s_cbranch_vccnz L_lwM
L_lwokM:
  v_max_f32 v48, v18, v19
  v_sub_f32 v18, v18, v48
  v_exp_f32 v18, v18
  v_add_f32 v40, v40, v41
  v_add_f32 v42, v42, v43
  v_add_f32 v40, v40, v42
  v_sub_f32 v19, v19, v48
  v_exp_f32 v19, v19
  v_add_f32 v44, v44, v45
  v_add_f32 v46, v46, v47
  v_add_f32 v44, v44, v46
  v_mul_f32 v49, v18, v40
  v_fmac_f32 v49, v19, v44
  v_rcp_f32 v20, v49
  v_log_f32 v21, v49
  s_nop 0
  v_mul_f32 v18, v18, v20
  v_mul_f32 v19, v19, v20
  v_add_f32 v48, v48, v21
  s_mov_b32 s63, 8388608
L_lwE:
  ds_read_b32 v20, v54 offset:272
  ds_read_b32 v21, v54 offset:276
  ds_read_b128 v[8:11], v52 offset:2560
  ds_read_b128 v[12:15], v52 offset:3072
  s_sub_u32 s63, s63, 1
  s_waitcnt lgkmcnt(0)
  s_cbranch_scc1 L_lwokE
  v_min_u32 v20, v20, v21
  v_cmp_eq_u32 vcc, 0, v20
  s_cbranch_vccnz L_lwE
L_lwokE:
  v_mul_f32 v28, v18, v8
  v_mul_f32 v29, v18, v9
  v_mul_f32 v30, v18, v10
  v_mul_f32 v31, v18, v11
  v_fmac_f32 v28, v19, v12
  v_fmac_f32 v29, v19, v13
  v_fmac_f32 v30, v19, v14
  v_fmac_f32 v31, v19, v15
  v_bfi_b32 v28, v193, v192, v28
  v_bfi_b32 v29, v193, v192, v29
  v_bfi_b32 v30, v193, v192, v30
  v_bfi_b32 v31, v193, v192, v31
  v_cndmask_b32_e64 v28, v28, v48, s[72:73]
  v_cndmask_b32_e64 v29, v29, v192, s[72:73]
  v_cndmask_b32_e64 v30, v30, v48, s[72:73]
  v_cndmask_b32_e64 v31, v31, v192, s[72:73]
  s_mov_b32 exec_hi, 15
  buffer_store_dwordx4 v[28:31], v1, s[20:23], s69 offen sc1
  s_mov_b32 exec_hi, -1
  s_mov_b32 s63, 524288
L_pollA:
  buffer_load_dwordx2 v[72:73], v38, s[20:23], s62 offen offset:512 sc1
  buffer_load_dwordx4 v[56:59], v53, s[20:23], s62 offen offset:0 sc1
  buffer_load_dwordx4 v[60:63], v53, s[20:23], s62 offen offset:1280 sc1
  buffer_load_dwordx4 v[64:67], v53, s[20:23], s62 offen offset:2560 sc1
  buffer_load_dwordx4 v[68:71], v53, s[20:23], s62 offen offset:3840 sc1
  s_sub_u32 s63, s63, 1
  s_waitcnt vmcnt(0)
  s_cbranch_scc1 L_pollokA
  v_bitop3_b32 v40, v56, v57, v192 bitop3:0x7e
  v_bitop3_b32 v42, v58, v59, v192 bitop3:0x7e
  v_or_b32 v40, v40, v42
  v_bitop3_b32 v41, v60, v61, v192 bitop3:0x7e
  v_bitop3_b32 v42, v62, v63, v192 bitop3:0x7e
  v_or3_b32 v40, v40, v41, v42
  v_bitop3_b32 v41, v64, v65, v192 bitop3:0x7e
  v_bitop3_b32 v42, v66, v67, v192 bitop3:0x7e
  v_or3_b32 v40, v40, v41, v42
  v_bitop3_b32 v41, v68, v69, v192 bitop3:0x7e
  v_bitop3_b32 v42, v70, v71, v192 bitop3:0x7e
  v_or3_b32 v40, v40, v41, v42
  v_xor_b32 v41, v73, v192
  v_and_or_b32 v40, v40, v193, v41
  v_cmp_ne_u32 vcc, 0, v40
  s_cbranch_vccnz L_pollA
L_pollokA:
  v_mov_b32 v48, v72
  v_bfi_b32 v56, v193, v199, v56
  v_bfi_b32 v57, v193, v199, v57
  v_bfi_b32 v58, v193, v199, v58
  v_bfi_b32 v59, v193, v199, v59
  v_max_f32_dpp v48, v48, v48 quad_perm:[1,0,3,2] row_mask:0xf bank_mask:0xf
  v_bfi_b32 v60, v193, v199, v60
  v_bfi_b32 v61, v193, v199, v61
  v_bfi_b32 v62, v193, v199, v62
  v_bfi_b32 v63, v193, v199, v63
  v_max_f32_dpp v48, v48, v48 quad_perm:[2,3,0,1] row_mask:0xf bank_mask:0xf
  v_bfi_b32 v64, v193, v199, v64
  v_bfi_b32 v65, v193, v199, v65
  v_bfi_b32 v66, v193, v199, v66
  v_bfi_b32 v67, v193, v199, v67
  v_max_f32_dpp v48, v48, v48 row_half_mirror row_mask:0xf bank_mask:0xf
  v_sub_f32 v72, v72, v48
  v_exp_f32 v72, v72
  v_bfi_b32 v68, v193, v199, v68
  v_bfi_b32 v69, v193, v199, v69
  v_mov_b32 v49, v72
  v_bfi_b32 v70, v193, v199, v70
  v_bfi_b32 v71, v193, v199, v71
  v_mul_f32_dpp v28, v72, v56 row_newbcast:0 row_mask:0xf bank_mask:0xf
  v_mul_f32_dpp v29, v72, v57 row_newbcast:0 row_mask:0xf bank_mask:0xf
  v_mul_f32_dpp v30, v72, v58 row_newbcast:0 row_mask:0xf bank_mask:0xf
  v_mul_f32_dpp v31, v72, v59 row_newbcast:0 row_mask:0xf bank_mask:0xf
  v_add_f32_dpp v49, v49, v49 quad_perm:[1,0,3,2] row_mask:0xf bank_mask:0xf
  v_fmac_f32_dpp v28, v72, v60 row_newbcast:2 row_mask:0xf bank_mask:0xf
  v_fmac_f32_dpp v29, v72, v61 row_newbcast:2 row_mask:0xf bank_mask:0xf
  v_fmac_f32_dpp v30, v72, v62 row_newbcast:2 row_mask:0xf bank_mask:0xf
  v_fmac_f32_dpp v31, v72, v63 row_newbcast:2 row_mask:0xf bank_mask:0xf
  v_add_f32_dpp v49, v49, v49 quad_perm:[2,3,0,1] row_mask:0xf bank_mask:0xf
  v_fmac_f32_dpp v28, v72, v64 row_newbcast:4 row_mask:0xf bank_mask:0xf
  v_fmac_f32_dpp v29, v72, v65 row_newbcast:4 row_mask:0xf bank_mask:0xf
  v_fmac_f32_dpp v30, v72, v66 row_newbcast:4 row_mask:0xf bank_mask:0xf
  v_fmac_f32_dpp v31, v72, v67 row_newbcast:4 row_mask:0xf bank_mask:0xf
  v_add_f32_dpp v49, v49, v49 row_half_mirror row_mask:0xf bank_mask:0xf
  v_fmac_f32_dpp v28, v72, v68 row_newbcast:6 row_mask:0xf bank_mask:0xf
  v_fmac_f32_dpp v29, v72, v69 row_newbcast:6 row_mask:0xf bank_mask:0xf
  v_fmac_f32_dpp v30, v72, v70 row_newbcast:6 row_mask:0xf bank_mask:0xf
  v_fmac_f32_dpp v31, v72, v71 row_newbcast:6 row_mask:0xf bank_mask:0xf
  v_rcp_f32 v49, v49
  s_nop 0
  v_permlane32_swap_b32 v28, v30
  v_permlane32_swap_b32 v29, v31
  v_add_f32 v17, v28, v30
  v_add_f32 v18, v29, v31
  v_mul_f32 v17, v17, v49
  v_mul_f32 v18, v18, v49
  v_cvt_pk_bf16_f32 v50, v17, v17
  v_cvt_pk_bf16_f32 v51, v18, v18
  ds_write_b64 v3, v[50:51] offset:4160
  ds_write_b32 v54, v194 offset:284
  s_cmp_lg_u32 s78, 0
  s_cbranch_scc1 L_fin
  s_mov_b32 s74, -1
L_final:
  v_lshlrev_b32 v60, 16, v36
  v_and_b32 v61, s76, v36
  v_lshlrev_b32 v62, 16, v37
  v_and_b32 v63, s76, v37
  s_mov_b32 s63, 8388608
L_lwP:
  ds_read_b32 v17, v54 offset:292
  s_sub_u32 s63, s63, 1
  s_waitcnt lgkmcnt(0)
  s_cbranch_scc1 L_lwokP
  v_cmp_eq_u32 vcc, 0, v17
  s_cbranch_vccnz L_lwP
L_lwokP:
  s_mov_b32 exec_hi, 0x0fffffff
  s_mov_b32 s63, 524288
L_pollF:
  buffer_load_dwordx4 v[76:79], v39, s[20:23], s7 offen sc1
  s_sub_u32 s63, s63, 1
  s_waitcnt vmcnt(0)
  s_cbranch_scc1 L_pollokF
  v_bitop3_b32 v40, v76, v77, v192 bitop3:0x7e
  v_bitop3_b32 v42, v78, v79, v192 bitop3:0x7e
  v_or_b32 v40, v40, v42
  v_and_b32 v40, v194, v40
  v_cmp_ne_u32 vcc, 0, v40
  s_cbranch_vccz L_pollokF
  s_mov_b64 exec, vcc
  s_branch L_pollF
L_pollokF:
  s_mov_b32 exec_lo, -1
  s_mov_b32 exec_hi, 0x0fffffff
  v_and_b32 v17, 0x100, v76
  v_cmp_ne_u32 vcc, 0, v17
  v_and_b32 v76, 0xfffffeff, v76
  s_and_b32 s74, s74, vcc_lo
  v_bfi_b32 v76, v194, v199, v76
  v_bfi_b32 v77, v194, v199, v77
  v_bfi_b32 v78, v194, v199, v78
  v_bfi_b32 v79, v194, v199, v79
  s_mov_b64 exec, -1
  v_add_f32_dpp v76, v76, v76 quad_perm:[1,0,3,2] row_mask:0xf bank_mask:0xf
  v_add_f32_dpp v77, v77, v77 quad_perm:[1,0,3,2] row_mask:0xf bank_mask:0xf
  v_add_f32_dpp v78, v78, v78 quad_perm:[1,0,3,2] row_mask:0xf bank_mask:0xf
  v_add_f32_dpp v79, v79, v79 quad_perm:[1,0,3,2] row_mask:0xf bank_mask:0xf
  v_add_f32_dpp v76, v76, v76 quad_perm:[2,3,0,1] row_mask:0xf bank_mask:0xf
  v_add_f32_dpp v77, v77, v77 quad_perm:[2,3,0,1] row_mask:0xf bank_mask:0xf
  v_add_f32_dpp v78, v78, v78 quad_perm:[2,3,0,1] row_mask:0xf bank_mask:0xf
  v_add_f32_dpp v79, v79, v79 quad_perm:[2,3,0,1] row_mask:0xf bank_mask:0xf
  v_add_f32_dpp v76, v76, v76 row_half_mirror row_mask:0xf bank_mask:0xf
  v_add_f32_dpp v77, v77, v77 row_half_mirror row_mask:0xf bank_mask:0xf
  v_add_f32_dpp v78, v78, v78 row_half_mirror row_mask:0xf bank_mask:0xf
  v_add_f32_dpp v79, v79, v79 row_half_mirror row_mask:0xf bank_mask:0xf
  v_add_f32_dpp v76, v76, v76 row_mirror row_mask:0xf bank_mask:0xf
  v_add_f32_dpp v77, v77, v77 row_mirror row_mask:0xf bank_mask:0xf
  v_add_f32_dpp v78, v78, v78 row_mirror row_mask:0xf bank_mask:0xf
  v_add_f32_dpp v79, v79, v79 row_mirror row_mask:0xf bank_mask:0xf
  v_add_f32_dpp v76, v76, v76 row_bcast:15 row_mask:0xa bank_mask:0xf
  v_add_f32_dpp v77, v77, v77 row_bcast:15 row_mask:0xa bank_mask:0xf
  v_add_f32_dpp v78, v78, v78 row_bcast:15 row_mask:0xa bank_mask:0xf
  v_add_f32_dpp v79, v79, v79 row_bcast:15 row_mask:0xa bank_mask:0xf
  v_cvt_pk_bf16_f32 v76, v76, v76
  v_and_b32 v76, s76, v76
  v_cvt_pk_bf16_f32 v77, v77, v77
  v_and_b32 v77, s76, v77
  v_cvt_pk_bf16_f32 v78, v78, v78
  v_and_b32 v78, s76, v78
  v_cvt_pk_bf16_f32 v79, v79, v79
  v_and_b32 v79, s76, v79
  v_add_f32 v60, v60, v76
  v_add_f32 v61, v61, v77
  v_add_f32 v62, v62, v78
  v_add_f32 v63, v63, v79
  v_readlane_b32 s65, v76, 63
  v_readlane_b32 s66, v77, 63
  v_readlane_b32 s67, v78, 63
  v_readlane_b32 s68, v79, 63
  v_cvt_pk_bf16_f32 v60, v60, v60
  v_and_b32 v60, s76, v60
  v_cvt_pk_bf16_f32 v61, v61, v61
  v_and_b32 v61, s76, v61
  v_cvt_pk_bf16_f32 v62, v62, v62
  v_and_b32 v62, s76, v62
  v_cvt_pk_bf16_f32 v63, v63, v63
  v_and_b32 v63, s76, v63
  v_add_f32 v60, s65, v60
  v_add_f32 v61, s66, v61
  v_add_f32 v62, s67, v62
  v_add_f32 v63, s68, v63
  v_cvt_pk_bf16_f32 v18, v60, v61
  v_cvt_pk_bf16_f32 v19, v62, v63
  s_mov_b64 exec, 0x10000
  buffer_store_dwordx2 v[18:19], v54, s[28:31], s64 offen
  s_cmp_lg_u32 s4, 0
  s_cbranch_scc1 L_fin
  s_cmp_eq_u32 s74, 0
  s_cbranch_scc1 L_allfin
  s_mov_b64 exec, -1
  s_ff1_i32_b32 s65, s74
  s_bitset0_b32 s74, s65
  s_lshl_b32 s64, s5, 8
  s_lshl_b32 s66, s65, 3
  s_add_u32 s64, s64, s66
  s_lshl_b32 s7, s5, 15
  s_lshl_b32 s66, s65, 4
  s_add_u32 s7, s7, s66
  s_add_u32 s7, s7, 786432
  buffer_load_dwordx2 v[36:37], v54, s[16:19], s64 offen
  v_mov_b32 v76, 0
  v_mov_b32 v77, 0
  v_mov_b32 v78, 0
  v_mov_b32 v79, 0
  s_waitcnt vmcnt(0)
  s_branch L_final
L_allfin:
  s_cmp_lg_u32 s2, 0
  s_cbranch_scc1 L_fin
  buffer_store_dword v192, v54, s[20:23], 0 offen offset:0
L_fin:
L_end:
  s_endpgm
L_stream:
  s_mov_b32 s24, s48
  s_mov_b32 s25, s49
  s_mov_b32 s26, 7340032
  s_mov_b32 s27, 0x20000
  s_mov_b32 s28, s50
  s_mov_b32 s29, s51
  s_mov_b32 s30, 7340032
  s_mov_b32 s31, 0x20000
  v_lshrrev_b32 v3, 3, v0
  v_mul_u32_u24 v3, 28672, v3
  v_and_b32 v21, 7, v0
  v_lshl_add_u32 v3, v21, 4, v3
  s_lshr_b32 s69, s77, 1
  s_lshl_b32 s69, s69, 8
  s_add_u32 s69, s69, s3
  s_mul_i32 s69, s69, 7168
  s_lshl_b32 s67, s71, 8
  s_add_u32 s69, s69, s67
  s_and_b32 s67, s77, 1
  s_lshl_b32 s67, s67, 7
  s_add_u32 s69, s69, s67
  s_mov_b32 s8, s38
  s_mov_b32 s9, s39
  s_mov_b32 s10, 536870912
  s_mov_b32 s11, 0x20000
  s_mov_b32 s12, s40
  s_mov_b32 s13, s41
  s_mov_b32 s14, 536870912
  s_mov_b32 s15, 0x20000
  s_lshl_b32 s62, s5, 9
  s_lshl_b32 s66, s3, 8
  s_or_b32 s62, s62, s66
  v_lshl_add_u32 v184, v19, 4, s62
  s_lshl_b32 s62, s4, 24
  s_add_u32 s78, s62, 262144
  v_bfe_u32 v185, v0, 4, 1
  v_mul_u32_u24 v185, 8192, v185
  v_xor_b32 v184, v184, v185
  v_bfe_u32 v185, v0, 5, 1
  v_mul_u32_u24 v185, 32768, v185
  v_xor_b32 v184, v184, v185
  v_xor_b32 v185, 4096, v184
  v_xor_b32 v186, 16384, v184
  v_xor_b32 v187, 20480, v184
  v_xor_b32 v188, 65536, v184
  v_xor_b32 v189, 69632, v184
  v_xor_b32 v190, 81920, v184
  v_xor_b32 v191, 86016, v184
  s_barrier
  s_cmp_ge_u32 s71, 28
  s_cbranch_scc1 L_noffn
  buffer_load_dwordx4 v[56:59], v3, s[24:27], s69 offen nt
  s_add_u32 s69, s69, 14336
  buffer_load_dwordx4 v[60:63], v3, s[24:27], s69 offen nt
  s_add_u32 s69, s69, 215040
  buffer_load_dwordx4 v[64:67], v3, s[24:27], s69 offen nt
  s_add_u32 s69, s69, 14336
  buffer_load_dwordx4 v[68:71], v3, s[24:27], s69 offen nt
  s_add_u32 s69, s69, 215040
  buffer_load_dwordx4 v[72:75], v3, s[24:27], s69 offen nt
  s_add_u32 s69, s69, 14336
  buffer_load_dwordx4 v[76:79], v3, s[24:27], s69 offen nt
  s_add_u32 s69, s69, 215040
  buffer_load_dwordx4 v[80:83], v3, s[24:27], s69 offen nt
  s_add_u32 s69, s69, 14336
  buffer_load_dwordx4 v[84:87], v3, s[24:27], s69 offen nt
  s_add_u32 s69, s69, 215040
  buffer_load_dwordx4 v[88:91], v3, s[24:27], s69 offen nt
  s_add_u32 s69, s69, 14336
  buffer_load_dwordx4 v[92:95], v3, s[24:27], s69 offen nt
  s_add_u32 s69, s69, 215040
  buffer_load_dwordx4 v[96:99], v3, s[24:27], s69 offen nt
  s_add_u32 s69, s69, 14336
  buffer_load_dwordx4 v[100:103], v3, s[24:27], s69 offen nt
  s_add_u32 s69, s69, 215040
  buffer_load_dwordx4 v[104:107], v3, s[24:27], s69 offen nt
  s_add_u32 s69, s69, 14336
  buffer_load_dwordx4 v[108:111], v3, s[24:27], s69 offen nt
  s_add_u32 s69, s69, 215040
  buffer_load_dwordx4 v[112:115], v3, s[24:27], s69 offen nt
  s_add_u32 s69, s69, 14336
  buffer_load_dwordx4 v[116:119], v3, s[24:27], s69 offen nt
  s_sub_u32 s69, s69, 1619968
  v_mov_b32 v28, 0
  v_mov_b32 v29, 0
  v_mov_b32 v30, 0
  v_mov_b32 v31, 0
  v_mov_b32 v32, 0
  v_mov_b32 v33, 0
  v_mov_b32 v34, 0
  v_mov_b32 v35, 0
  s_waitcnt vmcnt(16)
  v_lshlrev_b32 v40, 16, v8
  v_and_b32 v8, s76, v8
  v_lshlrev_b32 v41, 16, v9
  v_and_b32 v9, s76, v9
  v_lshlrev_b32 v42, 16, v10
  v_and_b32 v10, s76, v10
  v_lshlrev_b32 v43, 16, v11
  v_and_b32 v11, s76, v11
  v_lshlrev_b32 v44, 16, v12
  v_and_b32 v12, s76, v12
  v_lshlrev_b32 v45, 16, v13
  v_and_b32 v13, s76, v13
  v_lshlrev_b32 v46, 16, v14
  v_and_b32 v14, s76, v14
  v_lshlrev_b32 v47, 16, v15
  v_and_b32 v15, s76, v15
  v_add_f32 v17, v40, v8
  v_add_f32 v18, v41, v9
  v_add_f32 v17, v17, v18
  v_add_f32 v18, v42, v10
  v_add_f32 v17, v17, v18
  v_add_f32 v18, v43, v11
  v_add_f32 v17, v17, v18
  v_add_f32 v18, v44, v12
  v_add_f32 v17, v17, v18
  v_add_f32 v18, v45, v13
  v_add_f32 v17, v17, v18
  v_add_f32 v18, v46, v14
  v_add_f32 v17, v17, v18
  v_add_f32 v18, v47, v15
  v_add_f32 v17, v17, v18
  s_nop 1
  v_add_f32_dpp v17, v17, v17 quad_perm:[1,0,3,2] row_mask:0xf bank_mask:0xf
  s_nop 1
  v_add_f32_dpp v17, v17, v17 quad_perm:[2,3,0,1] row_mask:0xf bank_mask:0xf
  s_nop 1
  v_add_f32_dpp v17, v17, v17 row_half_mirror row_mask:0xf bank_mask:0xf
  s_nop 1
  v_add_f32_dpp v17, v17, v17 row_mirror row_mask:0xf bank_mask:0xf
  s_nop 0
  v_readlane_b32 s65, v17, 0
  v_readlane_b32 s66, v17, 16
  v_readlane_b32 s67, v17, 32
  v_readlane_b32 s68, v17, 48
  s_nop 0
  v_mov_b32 v17, s65
  v_add_f32 v17, s66, v17
  v_add_f32 v17, s67, v17
  v_add_f32 v17, s68, v17
  v_mul_f32 v17, 0x3a800000, v17
  v_mov_b32 v18, 0
  v_sub_f32 v40, v40, v17
  v_sub_f32 v8, v8, v17
  v_fmac_f32 v18, v40, v40
  v_fmac_f32 v18, v8, v8
  v_sub_f32 v41, v41, v17
  v_sub_f32 v9, v9, v17
  v_fmac_f32 v18, v41, v41
  v_fmac_f32 v18, v9, v9
  v_sub_f32 v42, v42, v17
  v_sub_f32 v10, v10, v17
  v_fmac_f32 v18, v42, v42
  v_fmac_f32 v18, v10, v10
  v_sub_f32 v43, v43, v17
  v_sub_f32 v11, v11, v17
  v_fmac_f32 v18, v43, v43
  v_fmac_f32 v18, v11, v11
  v_sub_f32 v44, v44, v17
  v_sub_f32 v12, v12, v17
  v_fmac_f32 v18, v44, v44
  v_fmac_f32 v18, v12, v12
  v_sub_f32 v45, v45, v17
  v_sub_f32 v13, v13, v17
  v_fmac_f32 v18, v45, v45
  v_fmac_f32 v18, v13, v13
  v_sub_f32 v46, v46, v17
  v_sub_f32 v14, v14, v17
  v_fmac_f32 v18, v46, v46
  v_fmac_f32 v18, v14, v14
  v_sub_f32 v47, v47, v17
  v_sub_f32 v15, v15, v17
  v_fmac_f32 v18, v47, v47
  v_fmac_f32 v18, v15, v15
  s_nop 1
  v_add_f32_dpp v18, v18, v18 quad_perm:[1,0,3,2] row_mask:0xf bank_mask:0xf
  s_nop 1
  v_add_f32_dpp v18, v18, v18 quad_perm:[2,3,0,1] row_mask:0xf bank_mask:0xf
  s_nop 1
  v_add_f32_dpp v18, v18, v18 row_half_mirror row_mask:0xf bank_mask:0xf
  s_nop 1
  v_add_f32_dpp v18, v18, v18 row_mirror row_mask:0xf bank_mask:0xf
  s_nop 0
  v_readlane_b32 s65, v18, 0
  v_readlane_b32 s66, v18, 16
  v_readlane_b32 s67, v18, 32
  v_readlane_b32 s68, v18, 48
  s_nop 0
  v_mov_b32 v18, s65
  v_add_f32 v18, s66, v18
  v_add_f32 v18, s67, v18
  v_add_f32 v18, s68, v18
  v_mul_f32 v18, 0x3a800000, v18
  v_cvt_pk_bf16_f32 v17, v17, v17
  v_and_b32 v17, s76, v17
  v_cvt_pk_bf16_f32 v18, v18, v18
  v_and_b32 v18, s76, v18
  v_add_f32 v18, 0x3727c5ac, v18
  v_cvt_pk_bf16_f32 v18, v18, v18
  v_and_b32 v18, s76, v18
  v_sqrt_f32 v18, v18
  s_nop 0
  v_cvt_pk_bf16_f32 v18, v18, v18
  v_and_b32 v18, s76, v18
  v_rcp_f32 v18, v18
  v_lshlrev_b32 v4, 16, v202
  v_and_b32 v5, s76, v202
  v_lshlrev_b32 v6, 16, v203
  v_and_b32 v7, s76, v203
  v_sub_f32 v4, v4, v17
  v_sub_f32 v5, v5, v17
  v_sub_f32 v6, v6, v17
  v_sub_f32 v7, v7, v17
  v_cvt_pk_bf16_f32 v4, v4, v4
  v_and_b32 v4, s76, v4
  v_cvt_pk_bf16_f32 v5, v5, v5
  v_and_b32 v5, s76, v5
  v_cvt_pk_bf16_f32 v6, v6, v6
  v_and_b32 v6, s76, v6
  v_cvt_pk_bf16_f32 v7, v7, v7
  v_and_b32 v7, s76, v7
  v_mul_f32 v4, v4, v18
  v_mul_f32 v5, v5, v18
  v_mul_f32 v6, v6, v18
  v_mul_f32 v7, v7, v18
  v_cvt_pk_bf16_f32 v4, v4, v4
  v_cvt_pk_bf16_f32 v5, v5, v5
  v_cvt_pk_bf16_f32 v6, v6, v6
  v_cvt_pk_bf16_f32 v7, v7, v7
  s_cmp_eq_u32 s3, 1
  s_cselect_b64 vcc, -1, 0
  v_cndmask_b32 v4, v4, v5, vcc
  v_cndmask_b32 v6, v6, v7, vcc
  s_nop 1
  v_and_b32_dpp v24, v4, v200 row_newbcast:0 row_mask:0xf bank_mask:0x1
  v_and_b32_dpp v25, v4, v200 row_newbcast:0 row_mask:0xf bank_mask:0x2
  v_and_b32_dpp v24, v4, v200 row_newbcast:8 row_mask:0xf bank_mask:0x4
  v_and_b32_dpp v25, v4, v200 row_newbcast:8 row_mask:0xf bank_mask:0x8
  s_waitcnt vmcnt(15)
  s_nop 0
  v_smfmac_f32_16x16x32_bf16 v[28:31], v[24:25], v[56:59], v198
  buffer_load_dwordx4 v[56:59], v3, s[28:31], s69 offen nt
  s_add_u32 s69, s69, 14336
  v_and_b32_dpp v24, v6, v200 row_newbcast:0 row_mask:0xf bank_mask:0x1
  v_and_b32_dpp v25, v6, v200 row_newbcast:0 row_mask:0xf bank_mask:0x2
  v_and_b32_dpp v24, v6, v200 row_newbcast:8 row_mask:0xf bank_mask:0x4
  v_and_b32_dpp v25, v6, v200 row_newbcast:8 row_mask:0xf bank_mask:0x8
  s_waitcnt vmcnt(15)
  s_nop 0
  v_smfmac_f32_16x16x32_bf16 v[28:31], v[24:25], v[60:63], v198
  buffer_load_dwordx4 v[60:63], v3, s[28:31], s69 offen nt
  s_add_u32 s69, s69, 215040
  v_and_b32_dpp v24, v4, v200 row_newbcast:1 row_mask:0xf bank_mask:0x1
  v_and_b32_dpp v25, v4, v200 row_newbcast:1 row_mask:0xf bank_mask:0x2
  v_and_b32_dpp v24, v4, v200 row_newbcast:9 row_mask:0xf bank_mask:0x4
  v_and_b32_dpp v25, v4, v200 row_newbcast:9 row_mask:0xf bank_mask:0x8
  s_waitcnt vmcnt(15)
  s_nop 0
  v_smfmac_f32_16x16x32_bf16 v[28:31], v[24:25], v[64:67], v198
  buffer_load_dwordx4 v[64:67], v3, s[28:31], s69 offen nt
  s_add_u32 s69, s69, 14336
  v_and_b32_dpp v24, v6, v200 row_newbcast:1 row_mask:0xf bank_mask:0x1
  v_and_b32_dpp v25, v6, v200 row_newbcast:1 row_mask:0xf bank_mask:0x2
  v_and_b32_dpp v24, v6, v200 row_newbcast:9 row_mask:0xf bank_mask:0x4
  v_and_b32_dpp v25, v6, v200 row_newbcast:9 row_mask:0xf bank_mask:0x8
  s_waitcnt vmcnt(15)
  s_nop 0
  v_smfmac_f32_16x16x32_bf16 v[28:31], v[24:25], v[68:71], v198
  buffer_load_dwordx4 v[68:71], v3, s[28:31], s69 offen nt
  s_add_u32 s69, s69, 215040
  v_and_b32_dpp v24, v4, v200 row_newbcast:2 row_mask:0xf bank_mask:0x1
  v_and_b32_dpp v25, v4, v200 row_newbcast:2 row_mask:0xf bank_mask:0x2
  v_and_b32_dpp v24, v4, v200 row_newbcast:10 row_mask:0xf bank_mask:0x4
  v_and_b32_dpp v25, v4, v200 row_newbcast:10 row_mask:0xf bank_mask:0x8
  s_waitcnt vmcnt(15)
  s_nop 0
  v_smfmac_f32_16x16x32_bf16 v[28:31], v[24:25], v[72:75], v198
  buffer_load_dwordx4 v[72:75], v3, s[28:31], s69 offen nt
  s_add_u32 s69, s69, 14336
  v_and_b32_dpp v24, v6, v200 row_newbcast:2 row_mask:0xf bank_mask:0x1
  v_and_b32_dpp v25, v6, v200 row_newbcast:2 row_mask:0xf bank_mask:0x2
  v_and_b32_dpp v24, v6, v200 row_newbcast:10 row_mask:0xf bank_mask:0x4
  v_and_b32_dpp v25, v6, v200 row_newbcast:10 row_mask:0xf bank_mask:0x8
  s_waitcnt vmcnt(15)
  s_nop 0
  v_smfmac_f32_16x16x32_bf16 v[28:31], v[24:25], v[76:79], v198
  buffer_load_dwordx4 v[76:79], v3, s[28:31], s69 offen nt
  s_add_u32 s69, s69, 215040
  v_and_b32_dpp v24, v4, v200 row_newbcast:3 row_mask:0xf bank_mask:0x1
  v_and_b32_dpp v25, v4, v200 row_newbcast:3 row_mask:0xf bank_mask:0x2
  v_and_b32_dpp v24, v4, v200 row_newbcast:11 row_mask:0xf bank_mask:0x4
  v_and_b32_dpp v25, v4, v200 row_newbcast:11 row_mask:0xf bank_mask:0x8
  s_waitcnt vmcnt(15)
  s_nop 0
  v_smfmac_f32_16x16x32_bf16 v[28:31], v[24:25], v[80:83], v198
  buffer_load_dwordx4 v[80:83], v3, s[28:31], s69 offen nt
  s_add_u32 s69, s69, 14336
  v_and_b32_dpp v24, v6, v200 row_newbcast:3 row_mask:0xf bank_mask:0x1
  v_and_b32_dpp v25, v6, v200 row_newbcast:3 row_mask:0xf bank_mask:0x2
  v_and_b32_dpp v24, v6, v200 row_newbcast:11 row_mask:0xf bank_mask:0x4
  v_and_b32_dpp v25, v6, v200 row_newbcast:11 row_mask:0xf bank_mask:0x8
  s_waitcnt vmcnt(15)
  s_nop 0
  v_smfmac_f32_16x16x32_bf16 v[28:31], v[24:25], v[84:87], v198
  buffer_load_dwordx4 v[84:87], v3, s[28:31], s69 offen nt
  s_add_u32 s69, s69, 215040
  v_and_b32_dpp v24, v4, v200 row_newbcast:4 row_mask:0xf bank_mask:0x1
  v_and_b32_dpp v25, v4, v200 row_newbcast:4 row_mask:0xf bank_mask:0x2
  v_and_b32_dpp v24, v4, v200 row_newbcast:12 row_mask:0xf bank_mask:0x4
  v_and_b32_dpp v25, v4, v200 row_newbcast:12 row_mask:0xf bank_mask:0x8
  s_waitcnt vmcnt(15)
  s_nop 0
  v_smfmac_f32_16x16x32_bf16 v[28:31], v[24:25], v[88:91], v198
  buffer_load_dwordx4 v[88:91], v3, s[28:31], s69 offen nt
  s_add_u32 s69, s69, 14336
  v_and_b32_dpp v24, v6, v200 row_newbcast:4 row_mask:0xf bank_mask:0x1
  v_and_b32_dpp v25, v6, v200 row_newbcast:4 row_mask:0xf bank_mask:0x2
  v_and_b32_dpp v24, v6, v200 row_newbcast:12 row_mask:0xf bank_mask:0x4
  v_and_b32_dpp v25, v6, v200 row_newbcast:12 row_mask:0xf bank_mask:0x8
  s_waitcnt vmcnt(15)
  s_nop 0
  v_smfmac_f32_16x16x32_bf16 v[28:31], v[24:25], v[92:95], v198
  buffer_load_dwordx4 v[92:95], v3, s[28:31], s69 offen nt
  s_add_u32 s69, s69, 215040
  v_and_b32_dpp v24, v4, v200 row_newbcast:5 row_mask:0xf bank_mask:0x1
  v_and_b32_dpp v25, v4, v200 row_newbcast:5 row_mask:0xf bank_mask:0x2
  v_and_b32_dpp v24, v4, v200 row_newbcast:13 row_mask:0xf bank_mask:0x4
  v_and_b32_dpp v25, v4, v200 row_newbcast:13 row_mask:0xf bank_mask:0x8
  s_waitcnt vmcnt(15)
  s_nop 0
  v_smfmac_f32_16x16x32_bf16 v[28:31], v[24:25], v[96:99], v198
  buffer_load_dwordx4 v[96:99], v3, s[28:31], s69 offen nt
  s_add_u32 s69, s69, 14336
  v_and_b32_dpp v24, v6, v200 row_newbcast:5 row_mask:0xf bank_mask:0x1
  v_and_b32_dpp v25, v6, v200 row_newbcast:5 row_mask:0xf bank_mask:0x2
  v_and_b32_dpp v24, v6, v200 row_newbcast:13 row_mask:0xf bank_mask:0x4
  v_and_b32_dpp v25, v6, v200 row_newbcast:13 row_mask:0xf bank_mask:0x8
  s_waitcnt vmcnt(15)
  s_nop 0
  v_smfmac_f32_16x16x32_bf16 v[28:31], v[24:25], v[100:103], v198
  buffer_load_dwordx4 v[100:103], v3, s[28:31], s69 offen nt
  s_add_u32 s69, s69, 215040
  v_and_b32_dpp v24, v4, v200 row_newbcast:6 row_mask:0xf bank_mask:0x1
  v_and_b32_dpp v25, v4, v200 row_newbcast:6 row_mask:0xf bank_mask:0x2
  v_and_b32_dpp v24, v4, v200 row_newbcast:14 row_mask:0xf bank_mask:0x4
  v_and_b32_dpp v25, v4, v200 row_newbcast:14 row_mask:0xf bank_mask:0x8
  s_waitcnt vmcnt(15)
  s_nop 0
  v_smfmac_f32_16x16x32_bf16 v[28:31], v[24:25], v[104:107], v198
  buffer_load_dwordx4 v[104:107], v3, s[28:31], s69 offen nt
  s_add_u32 s69, s69, 14336
  v_and_b32_dpp v24, v6, v200 row_newbcast:6 row_mask:0xf bank_mask:0x1
  v_and_b32_dpp v25, v6, v200 row_newbcast:6 row_mask:0xf bank_mask:0x2
  v_and_b32_dpp v24, v6, v200 row_newbcast:14 row_mask:0xf bank_mask:0x4
  v_and_b32_dpp v25, v6, v200 row_newbcast:14 row_mask:0xf bank_mask:0x8
  s_waitcnt vmcnt(15)
  s_nop 0
  v_smfmac_f32_16x16x32_bf16 v[28:31], v[24:25], v[108:111], v198
  buffer_load_dwordx4 v[108:111], v3, s[28:31], s69 offen nt
  s_add_u32 s69, s69, 215040
  v_and_b32_dpp v24, v4, v200 row_newbcast:7 row_mask:0xf bank_mask:0x1
  v_and_b32_dpp v25, v4, v200 row_newbcast:7 row_mask:0xf bank_mask:0x2
  v_and_b32_dpp v24, v4, v200 row_newbcast:15 row_mask:0xf bank_mask:0x4
  v_and_b32_dpp v25, v4, v200 row_newbcast:15 row_mask:0xf bank_mask:0x8
  s_waitcnt vmcnt(15)
  s_nop 0
  v_smfmac_f32_16x16x32_bf16 v[28:31], v[24:25], v[112:115], v198
  buffer_load_dwordx4 v[112:115], v3, s[28:31], s69 offen nt
  s_add_u32 s69, s69, 14336
  v_and_b32_dpp v24, v6, v200 row_newbcast:7 row_mask:0xf bank_mask:0x1
  v_and_b32_dpp v25, v6, v200 row_newbcast:7 row_mask:0xf bank_mask:0x2
  v_and_b32_dpp v24, v6, v200 row_newbcast:15 row_mask:0xf bank_mask:0x4
  v_and_b32_dpp v25, v6, v200 row_newbcast:15 row_mask:0xf bank_mask:0x8
  s_waitcnt vmcnt(15)
  s_nop 0
  v_smfmac_f32_16x16x32_bf16 v[28:31], v[24:25], v[116:119], v198
  buffer_load_dwordx4 v[116:119], v3, s[28:31], s69 offen nt
  v_and_b32_dpp v24, v4, v200 row_newbcast:0 row_mask:0xf bank_mask:0x1
  v_and_b32_dpp v25, v4, v200 row_newbcast:0 row_mask:0xf bank_mask:0x2
  v_and_b32_dpp v24, v4, v200 row_newbcast:8 row_mask:0xf bank_mask:0x4
  v_and_b32_dpp v25, v4, v200 row_newbcast:8 row_mask:0xf bank_mask:0x8
  s_waitcnt vmcnt(15)
  s_nop 0
  v_smfmac_f32_16x16x32_bf16 v[32:35], v[24:25], v[56:59], v198
  buffer_load_dwordx4 v[56:59], v184, s[8:11], s62 offen nt
  v_and_b32_dpp v24, v6, v200 row_newbcast:0 row_mask:0xf bank_mask:0x1
  v_and_b32_dpp v25, v6, v200 row_newbcast:0 row_mask:0xf bank_mask:0x2
  v_and_b32_dpp v24, v6, v200 row_newbcast:8 row_mask:0xf bank_mask:0x4
  v_and_b32_dpp v25, v6, v200 row_newbcast:8 row_mask:0xf bank_mask:0x8
  s_waitcnt vmcnt(15)
  s_nop 0
  v_smfmac_f32_16x16x32_bf16 v[32:35], v[24:25], v[60:63], v198
  buffer_load_dwordx4 v[60:63], v185, s[8:11], s62 offen nt
  v_and_b32_dpp v24, v4, v200 row_newbcast:1 row_mask:0xf bank_mask:0x1
  v_and_b32_dpp v25, v4, v200 row_newbcast:1 row_mask:0xf bank_mask:0x2
  v_and_b32_dpp v24, v4, v200 row_newbcast:9 row_mask:0xf bank_mask:0x4
  v_and_b32_dpp v25, v4, v200 row_newbcast:9 row_mask:0xf bank_mask:0x8
  s_waitcnt vmcnt(15)
  s_nop 0
  v_smfmac_f32_16x16x32_bf16 v[32:35], v[24:25], v[64:67], v198
  buffer_load_dwordx4 v[64:67], v186, s[8:11], s62 offen nt
  v_and_b32_dpp v24, v6, v200 row_newbcast:1 row_mask:0xf bank_mask:0x1
  v_and_b32_dpp v25, v6, v200 row_newbcast:1 row_mask:0xf bank_mask:0x2
  v_and_b32_dpp v24, v6, v200 row_newbcast:9 row_mask:0xf bank_mask:0x4
  v_and_b32_dpp v25, v6, v200 row_newbcast:9 row_mask:0xf bank_mask:0x8
  s_waitcnt vmcnt(15)
  s_nop 0
  v_smfmac_f32_16x16x32_bf16 v[32:35], v[24:25], v[68:71], v198
  buffer_load_dwordx4 v[68:71], v187, s[8:11], s62 offen nt
  v_and_b32_dpp v24, v4, v200 row_newbcast:2 row_mask:0xf bank_mask:0x1
  v_and_b32_dpp v25, v4, v200 row_newbcast:2 row_mask:0xf bank_mask:0x2
  v_and_b32_dpp v24, v4, v200 row_newbcast:10 row_mask:0xf bank_mask:0x4
  v_and_b32_dpp v25, v4, v200 row_newbcast:10 row_mask:0xf bank_mask:0x8
  s_waitcnt vmcnt(15)
  s_nop 0
  v_smfmac_f32_16x16x32_bf16 v[32:35], v[24:25], v[72:75], v198
  buffer_load_dwordx4 v[72:75], v188, s[8:11], s62 offen nt
  v_and_b32_dpp v24, v6, v200 row_newbcast:2 row_mask:0xf bank_mask:0x1
  v_and_b32_dpp v25, v6, v200 row_newbcast:2 row_mask:0xf bank_mask:0x2
  v_and_b32_dpp v24, v6, v200 row_newbcast:10 row_mask:0xf bank_mask:0x4
  v_and_b32_dpp v25, v6, v200 row_newbcast:10 row_mask:0xf bank_mask:0x8
  s_waitcnt vmcnt(15)
  s_nop 0
  v_smfmac_f32_16x16x32_bf16 v[32:35], v[24:25], v[76:79], v198
  buffer_load_dwordx4 v[76:79], v189, s[8:11], s62 offen nt
  v_and_b32_dpp v24, v4, v200 row_newbcast:3 row_mask:0xf bank_mask:0x1
  v_and_b32_dpp v25, v4, v200 row_newbcast:3 row_mask:0xf bank_mask:0x2
  v_and_b32_dpp v24, v4, v200 row_newbcast:11 row_mask:0xf bank_mask:0x4
  v_and_b32_dpp v25, v4, v200 row_newbcast:11 row_mask:0xf bank_mask:0x8
  s_waitcnt vmcnt(15)
  s_nop 0
  v_smfmac_f32_16x16x32_bf16 v[32:35], v[24:25], v[80:83], v198
  buffer_load_dwordx4 v[80:83], v190, s[8:11], s62 offen nt
  v_and_b32_dpp v24, v6, v200 row_newbcast:3 row_mask:0xf bank_mask:0x1
  v_and_b32_dpp v25, v6, v200 row_newbcast:3 row_mask:0xf bank_mask:0x2
  v_and_b32_dpp v24, v6, v200 row_newbcast:11 row_mask:0xf bank_mask:0x4
  v_and_b32_dpp v25, v6, v200 row_newbcast:11 row_mask:0xf bank_mask:0x8
  s_waitcnt vmcnt(15)
  s_nop 0
  v_smfmac_f32_16x16x32_bf16 v[32:35], v[24:25], v[84:87], v198
  buffer_load_dwordx4 v[84:87], v191, s[8:11], s62 offen nt
  v_and_b32_dpp v24, v4, v200 row_newbcast:4 row_mask:0xf bank_mask:0x1
  v_and_b32_dpp v25, v4, v200 row_newbcast:4 row_mask:0xf bank_mask:0x2
  v_and_b32_dpp v24, v4, v200 row_newbcast:12 row_mask:0xf bank_mask:0x4
  v_and_b32_dpp v25, v4, v200 row_newbcast:12 row_mask:0xf bank_mask:0x8
  s_waitcnt vmcnt(15)
  s_nop 0
  v_smfmac_f32_16x16x32_bf16 v[32:35], v[24:25], v[88:91], v198
  buffer_load_dwordx4 v[88:91], v184, s[8:11], s78 offen nt
  v_and_b32_dpp v24, v6, v200 row_newbcast:4 row_mask:0xf bank_mask:0x1
  v_and_b32_dpp v25, v6, v200 row_newbcast:4 row_mask:0xf bank_mask:0x2
  v_and_b32_dpp v24, v6, v200 row_newbcast:12 row_mask:0xf bank_mask:0x4
  v_and_b32_dpp v25, v6, v200 row_newbcast:12 row_mask:0xf bank_mask:0x8
  s_waitcnt vmcnt(15)
  s_nop 0
  v_smfmac_f32_16x16x32_bf16 v[32:35], v[24:25], v[92:95], v198
  buffer_load_dwordx4 v[92:95], v185, s[8:11], s78 offen nt
  v_and_b32_dpp v24, v4, v200 row_newbcast:5 row_mask:0xf bank_mask:0x1
  v_and_b32_dpp v25, v4, v200 row_newbcast:5 row_mask:0xf bank_mask:0x2
  v_and_b32_dpp v24, v4, v200 row_newbcast:13 row_mask:0xf bank_mask:0x4
  v_and_b32_dpp v25, v4, v200 row_newbcast:13 row_mask:0xf bank_mask:0x8
  s_waitcnt vmcnt(15)
  s_nop 0
  v_smfmac_f32_16x16x32_bf16 v[32:35], v[24:25], v[96:99], v198
  buffer_load_dwordx4 v[96:99], v186, s[8:11], s78 offen nt
  v_and_b32_dpp v24, v6, v200 row_newbcast:5 row_mask:0xf bank_mask:0x1
  v_and_b32_dpp v25, v6, v200 row_newbcast:5 row_mask:0xf bank_mask:0x2
  v_and_b32_dpp v24, v6, v200 row_newbcast:13 row_mask:0xf bank_mask:0x4
  v_and_b32_dpp v25, v6, v200 row_newbcast:13 row_mask:0xf bank_mask:0x8
  s_waitcnt vmcnt(15)
  s_nop 0
  v_smfmac_f32_16x16x32_bf16 v[32:35], v[24:25], v[100:103], v198
  buffer_load_dwordx4 v[100:103], v187, s[8:11], s78 offen nt
  v_and_b32_dpp v24, v4, v200 row_newbcast:6 row_mask:0xf bank_mask:0x1
  v_and_b32_dpp v25, v4, v200 row_newbcast:6 row_mask:0xf bank_mask:0x2
  v_and_b32_dpp v24, v4, v200 row_newbcast:14 row_mask:0xf bank_mask:0x4
  v_and_b32_dpp v25, v4, v200 row_newbcast:14 row_mask:0xf bank_mask:0x8
  s_waitcnt vmcnt(15)
  s_nop 0
  v_smfmac_f32_16x16x32_bf16 v[32:35], v[24:25], v[104:107], v198
  buffer_load_dwordx4 v[104:107], v188, s[8:11], s78 offen nt
  v_and_b32_dpp v24, v6, v200 row_newbcast:6 row_mask:0xf bank_mask:0x1
  v_and_b32_dpp v25, v6, v200 row_newbcast:6 row_mask:0xf bank_mask:0x2
  v_and_b32_dpp v24, v6, v200 row_newbcast:14 row_mask:0xf bank_mask:0x4
  v_and_b32_dpp v25, v6, v200 row_newbcast:14 row_mask:0xf bank_mask:0x8
  s_waitcnt vmcnt(15)
  s_nop 0
  v_smfmac_f32_16x16x32_bf16 v[32:35], v[24:25], v[108:111], v198
  buffer_load_dwordx4 v[108:111], v189, s[8:11], s78 offen nt
  v_and_b32_dpp v24, v4, v200 row_newbcast:7 row_mask:0xf bank_mask:0x1
  v_and_b32_dpp v25, v4, v200 row_newbcast:7 row_mask:0xf bank_mask:0x2
  v_and_b32_dpp v24, v4, v200 row_newbcast:15 row_mask:0xf bank_mask:0x4
  v_and_b32_dpp v25, v4, v200 row_newbcast:15 row_mask:0xf bank_mask:0x8
  s_waitcnt vmcnt(15)
  s_nop 0
  v_smfmac_f32_16x16x32_bf16 v[32:35], v[24:25], v[112:115], v198
  buffer_load_dwordx4 v[112:115], v190, s[8:11], s78 offen nt
  v_and_b32_dpp v24, v6, v200 row_newbcast:7 row_mask:0xf bank_mask:0x1
  v_and_b32_dpp v25, v6, v200 row_newbcast:7 row_mask:0xf bank_mask:0x2
  v_and_b32_dpp v24, v6, v200 row_newbcast:15 row_mask:0xf bank_mask:0x4
  v_and_b32_dpp v25, v6, v200 row_newbcast:15 row_mask:0xf bank_mask:0x8
  s_waitcnt vmcnt(15)
  s_nop 0
  v_smfmac_f32_16x16x32_bf16 v[32:35], v[24:25], v[116:119], v198
  buffer_load_dwordx4 v[116:119], v191, s[8:11], s78 offen nt
  s_lshl_b32 s66, s3, 9
  v_add_u32 v17, s66, v201
  s_nop 11
  s_mov_b32 exec_lo, 0x00ff00ff
  s_mov_b32 exec_hi, 0xff00ff00
  ds_write_b128 v17, v[28:31] offset:512
  ds_write_b128 v17, v[32:35] offset:1536
  s_mov_b64 exec, -1
  s_branch L_kvstart
L_noffn:
  buffer_load_dwordx4 v[56:59], v184, s[8:11], s62 offen nt
  buffer_load_dwordx4 v[60:63], v185, s[8:11], s62 offen nt
  buffer_load_dwordx4 v[64:67], v186, s[8:11], s62 offen nt
  buffer_load_dwordx4 v[68:71], v187, s[8:11], s62 offen nt
  buffer_load_dwordx4 v[72:75], v188, s[8:11], s62 offen nt
  buffer_load_dwordx4 v[76:79], v189, s[8:11], s62 offen nt
  buffer_load_dwordx4 v[80:83], v190, s[8:11], s62 offen nt
  buffer_load_dwordx4 v[84:87], v191, s[8:11], s62 offen nt
  buffer_load_dwordx4 v[88:91], v184, s[8:11], s78 offen nt
  buffer_load_dwordx4 v[92:95], v185, s[8:11], s78 offen nt
  buffer_load_dwordx4 v[96:99], v186, s[8:11], s78 offen nt
  buffer_load_dwordx4 v[100:103], v187, s[8:11], s78 offen nt
  buffer_load_dwordx4 v[104:107], v188, s[8:11], s78 offen nt
  buffer_load_dwordx4 v[108:111], v189, s[8:11], s78 offen nt
  buffer_load_dwordx4 v[112:115], v190, s[8:11], s78 offen nt
  buffer_load_dwordx4 v[116:119], v191, s[8:11], s78 offen nt
  s_waitcnt vmcnt(16)
L_kvstart:
  v_mov_b32 v28, 0
  v_mov_b32 v29, 0
  v_mov_b32 v30, 0
  v_mov_b32 v31, 0
  v_mov_b32 v48, 0xff61b1e6
  v_mov_b32 v49, 0
  s_mov_b32 s72, 0xcccccccc
  s_mov_b32 s73, 0xcccccccc
  s_mov_b32 s74, 0x3db504f3
  s_mov_b32 s75, 0x3fb8aa3b
  v_and_b32 v17, 15, v0
  v_lshlrev_b32 v17, 4, v17
  s_cmp_lt_u32 s71, 28
  s_cselect_b32 s68, 7340032, 0
  s_add_u32 s67, s71, 32
  s_cmp_eq_u32 s3, 0
  s_cselect_b32 s24, s52, s44
  s_cselect_b32 s25, s53, s45
  s_cselect_b32 s26, s68, 8388608
  s_cselect_b32 s65, s71, s4
  s_cselect_b32 s66, s77, s5
  s_cselect_b32 s67, s67, s4
  s_lshr_b32 s68, s65, 4
  s_xor_b32 s68, s68, s3
  s_and_b32 s68, s68, 1
  s_lshl_b32 s69, s65, 18
  s_lshl_b32 s65, s66, 8
  s_add_u32 s69, s69, s65
  s_lshl_b32 s65, s68, 17
  s_add_u32 s69, s69, s65
  s_lshl_b32 s65, s68, 18
  s_sub_u32 s60, 102400, s65
  s_lshl_b32 s64, s66, 6
  s_add_u32 s64, s64, s67
  s_lshl_b32 s64, s64, 9
  s_add_u32 s64, s64, 786432
  v_lshrrev_b32 v22, 4, v0
  v_lshl_add_u32 v3, v22, 15, v17
  v_bfe_u32 v21, v0, 3, 1
  v_xor_b32 v21, s68, v21
  v_lshlrev_b32 v21, 5, v21
  v_lshl_add_u32 v21, v22, 3, v21
  v_and_b32 v22, 7, v0
  v_add_u32 v21, v21, v22
  s_lshl_b32 s65, s3, 14
  v_lshl_add_u32 v52, v0, 2, s65
  s_mov_b32 s28, 0xaaaaaaaa
  s_mov_b32 s29, 0xaaaaaaaa
  v_mov_b32 v53, 1
  s_mov_b32 s6, 0
  s_mov_b32 s7, 0
  s_mov_b32 s63, 0
  s_mov_b32 s61, 0
  s_mul_i32 s65, s3, 640
  v_mov_b32 v10, s65
  s_lshl_b32 s65, s3, 2
  v_mov_b32 v12, s65
  s_lshl_b32 s65, s3, 9
  v_lshl_add_u32 v13, v21, 3, s65
  v_add_u32 v14, s65, v55
  s_lshl_b32 s65, s3, 5
  v_lshrrev_b32 v15, 4, v0
  v_lshl_add_u32 v15, v15, 2, s65
  s_waitcnt lgkmcnt(0)
  s_barrier
  ds_read_b128 v[36:39], v17 offset:0
  ds_read_b32 v192, v54 offset:256
  s_waitcnt lgkmcnt(0)
  s_waitcnt vmcnt(15)
  v_dot2_f32_bf16 v120, v56, v36, 0
  v_dot2_f32_bf16 v120, v57, v37, v120
  v_dot2_f32_bf16 v120, v58, v38, v120
  v_dot2_f32_bf16 v120, v59, v39, v120
  s_waitcnt vmcnt(14)
  v_dot2_f32_bf16 v121, v60, v36, 0
  v_dot2_f32_bf16 v121, v61, v37, v121
  v_dot2_f32_bf16 v121, v62, v38, v121
  v_dot2_f32_bf16 v121, v63, v39, v121
  v_add_f32_dpp v120, v120, v120 row_ror:8 row_mask:0xf bank_mask:0x3
  s_nop 1
  v_add_f32_dpp v120, v121, v121 row_ror:8 row_mask:0xf bank_mask:0xc
  s_waitcnt vmcnt(13)
  v_dot2_f32_bf16 v122, v64, v36, 0
  v_dot2_f32_bf16 v122, v65, v37, v122
  v_dot2_f32_bf16 v122, v66, v38, v122
  v_dot2_f32_bf16 v122, v67, v39, v122
  s_waitcnt vmcnt(12)
  v_dot2_f32_bf16 v123, v68, v36, 0
  v_dot2_f32_bf16 v123, v69, v37, v123
  v_dot2_f32_bf16 v123, v70, v38, v123
  v_dot2_f32_bf16 v123, v71, v39, v123
  v_add_f32_dpp v122, v122, v122 row_ror:8 row_mask:0xf bank_mask:0x3
  s_nop 1
  v_add_f32_dpp v122, v123, v123 row_ror:8 row_mask:0xf bank_mask:0xc
  v_add_f32_dpp v120, v120, v120 row_half_mirror row_mask:0xf bank_mask:0x5
  s_nop 0
  v_add_f32_dpp v120, v122, v122 row_half_mirror row_mask:0xf bank_mask:0xa
  s_nop 1
  v_add_f32_dpp v120, v120, v120 quad_perm:[2,3,0,1] row_mask:0xf bank_mask:0xf
  s_waitcnt vmcnt(11)
  v_dot2_f32_bf16 v124, v72, v36, 0
  v_dot2_f32_bf16 v124, v73, v37, v124
  v_dot2_f32_bf16 v124, v74, v38, v124
  v_dot2_f32_bf16 v124, v75, v39, v124
  s_memrealtime s[34:35]
  ds_read_b64 v[8:9], v54 offset:264
  s_waitcnt vmcnt(10)
  v_dot2_f32_bf16 v125, v76, v36, 0
  v_dot2_f32_bf16 v125, v77, v37, v125
  v_dot2_f32_bf16 v125, v78, v38, v125
  v_dot2_f32_bf16 v125, v79, v39, v125
  v_add_f32_dpp v124, v124, v124 row_ror:8 row_mask:0xf bank_mask:0x3
  s_nop 1
  v_add_f32_dpp v124, v125, v125 row_ror:8 row_mask:0xf bank_mask:0xc
  s_branch L_aft
L_KS:
  s_waitcnt vmcnt(9)
  v_dot2_f32_bf16 v126, v80, v36, 0
  v_dot2_f32_bf16 v126, v81, v37, v126
  v_dot2_f32_bf16 v126, v82, v38, v126
  v_dot2_f32_bf16 v126, v83, v39, v126
  buffer_load_dwordx4 v[56:59], v184, s[8:11], s62 offen nt
  s_waitcnt vmcnt(9)
  v_dot2_f32_bf16 v127, v84, v36, 0
  v_dot2_f32_bf16 v127, v85, v37, v127
  v_dot2_f32_bf16 v127, v86, v38, v127
  v_dot2_f32_bf16 v127, v87, v39, v127
  buffer_load_dwordx4 v[60:63], v185, s[8:11], s62 offen nt
  v_add_f32_dpp v126, v126, v126 row_ror:8 row_mask:0xf bank_mask:0x3
  s_nop 1
  v_add_f32_dpp v126, v127, v127 row_ror:8 row_mask:0xf bank_mask:0xc
  v_add_f32_dpp v124, v124, v124 row_half_mirror row_mask:0xf bank_mask:0x5
  s_nop 0
  v_add_f32_dpp v124, v126, v126 row_half_mirror row_mask:0xf bank_mask:0xa
  s_nop 1
  v_add_f32_dpp v124, v124, v124 quad_perm:[2,3,0,1] row_mask:0xf bank_mask:0xf
  v_cndmask_b32_e64 v120, v120, v124, s[72:73]
  s_nop 1
  v_add_f32_dpp v120, v120, v120 quad_perm:[1,0,3,2] row_mask:0xf bank_mask:0xf
  s_waitcnt vmcnt(9)
  v_dot2_f32_bf16 v128, v88, v36, 0
  v_dot2_f32_bf16 v128, v89, v37, v128
  v_dot2_f32_bf16 v128, v90, v38, v128
  v_dot2_f32_bf16 v128, v91, v39, v128
  buffer_load_dwordx4 v[64:67], v186, s[8:11], s62 offen nt
  s_waitcnt vmcnt(9)
  v_dot2_f32_bf16 v129, v92, v36, 0
  v_dot2_f32_bf16 v129, v93, v37, v129
  v_dot2_f32_bf16 v129, v94, v38, v129
  v_dot2_f32_bf16 v129, v95, v39, v129
  buffer_load_dwordx4 v[68:71], v187, s[8:11], s62 offen nt
  v_add_f32_dpp v128, v128, v128 row_ror:8 row_mask:0xf bank_mask:0x3
  s_nop 1
  v_add_f32_dpp v128, v129, v129 row_ror:8 row_mask:0xf bank_mask:0xc
  s_waitcnt vmcnt(9)
  v_dot2_f32_bf16 v130, v96, v36, 0
  v_dot2_f32_bf16 v130, v97, v37, v130
  v_dot2_f32_bf16 v130, v98, v38, v130
  v_dot2_f32_bf16 v130, v99, v39, v130
  buffer_load_dwordx4 v[72:75], v188, s[8:11], s62 offen nt
  s_waitcnt vmcnt(9)
  v_dot2_f32_bf16 v131, v100, v36, 0
  v_dot2_f32_bf16 v131, v101, v37, v131
  v_dot2_f32_bf16 v131, v102, v38, v131
  v_dot2_f32_bf16 v131, v103, v39, v131
  buffer_load_dwordx4 v[76:79], v189, s[8:11], s62 offen nt
  v_add_f32_dpp v130, v130, v130 row_ror:8 row_mask:0xf bank_mask:0x3
  s_nop 1
  v_add_f32_dpp v130, v131, v131 row_ror:8 row_mask:0xf bank_mask:0xc
  v_add_f32_dpp v128, v128, v128 row_half_mirror row_mask:0xf bank_mask:0x5
  s_nop 0
  v_add_f32_dpp v128, v130, v130 row_half_mirror row_mask:0xf bank_mask:0xa
  s_nop 1
  v_add_f32_dpp v128, v128, v128 quad_perm:[2,3,0,1] row_mask:0xf bank_mask:0xf
  s_waitcnt vmcnt(9)
  v_dot2_f32_bf16 v132, v104, v36, 0
  v_dot2_f32_bf16 v132, v105, v37, v132
  v_dot2_f32_bf16 v132, v106, v38, v132
  v_dot2_f32_bf16 v132, v107, v39, v132
  buffer_load_dwordx4 v[80:83], v190, s[8:11], s62 offen nt
  s_waitcnt vmcnt(9)
  v_dot2_f32_bf16 v133, v108, v36, 0
  v_dot2_f32_bf16 v133, v109, v37, v133
  v_dot2_f32_bf16 v133, v110, v38, v133
  v_dot2_f32_bf16 v133, v111, v39, v133
  buffer_load_dwordx4 v[84:87], v191, s[8:11], s62 offen nt
  v_add_f32_dpp v132, v132, v132 row_ror:8 row_mask:0xf bank_mask:0x3
  s_nop 1
  v_add_f32_dpp v132, v133, v133 row_ror:8 row_mask:0xf bank_mask:0xc
  s_waitcnt vmcnt(9)
  v_dot2_f32_bf16 v134, v112, v36, 0
  v_dot2_f32_bf16 v134, v113, v37, v134
  v_dot2_f32_bf16 v134, v114, v38, v134
  v_dot2_f32_bf16 v134, v115, v39, v134
  buffer_load_dwordx4 v[88:91], v184, s[8:11], s78 offen nt
  s_waitcnt vmcnt(9)
  v_dot2_f32_bf16 v135, v116, v36, 0
  v_dot2_f32_bf16 v135, v117, v37, v135
  v_dot2_f32_bf16 v135, v118, v38, v135
  v_dot2_f32_bf16 v135, v119, v39, v135
  buffer_load_dwordx4 v[92:95], v185, s[8:11], s78 offen nt
  v_add_f32_dpp v134, v134, v134 row_ror:8 row_mask:0xf bank_mask:0x3
  s_nop 1
  v_add_f32_dpp v134, v135, v135 row_ror:8 row_mask:0xf bank_mask:0xc
  v_add_f32_dpp v132, v132, v132 row_half_mirror row_mask:0xf bank_mask:0x5
  s_nop 0
  v_add_f32_dpp v132, v134, v134 row_half_mirror row_mask:0xf bank_mask:0xa
  s_nop 1
  v_add_f32_dpp v132, v132, v132 quad_perm:[2,3,0,1] row_mask:0xf bank_mask:0xf
  v_cndmask_b32_e64 v128, v128, v132, s[72:73]
  s_nop 1
  v_add_f32_dpp v128, v128, v128 quad_perm:[1,0,3,2] row_mask:0xf bank_mask:0xf
  v_cndmask_b32_e64 v40, v120, v128, s[28:29]
  v_cvt_pk_bf16_f32 v40, v40, v40
  v_and_b32 v40, s76, v40
  v_mul_f32 v40, s74, v40
  v_cvt_pk_bf16_f32 v40, v40, v40
  v_and_b32 v40, s76, v40
  v_mul_f32 v40, s75, v40
  ds_write_b32 v52, v40 offset:5952
  v_max_f32 v48, v48, v40
  v_add_u32 v52, 256, v52
  s_waitcnt vmcnt(9)
  v_dot2_f32_bf16 v120, v56, v36, 0
  v_dot2_f32_bf16 v120, v57, v37, v120
  v_dot2_f32_bf16 v120, v58, v38, v120
  v_dot2_f32_bf16 v120, v59, v39, v120
  buffer_load_dwordx4 v[96:99], v186, s[8:11], s78 offen nt
  s_waitcnt vmcnt(9)
  v_dot2_f32_bf16 v121, v60, v36, 0
  v_dot2_f32_bf16 v121, v61, v37, v121
  v_dot2_f32_bf16 v121, v62, v38, v121
  v_dot2_f32_bf16 v121, v63, v39, v121
  buffer_load_dwordx4 v[100:103], v187, s[8:11], s78 offen nt
  v_add_f32_dpp v120, v120, v120 row_ror:8 row_mask:0xf bank_mask:0x3
  s_nop 1
  v_add_f32_dpp v120, v121, v121 row_ror:8 row_mask:0xf bank_mask:0xc
  s_waitcnt vmcnt(9)
  v_dot2_f32_bf16 v122, v64, v36, 0
  v_dot2_f32_bf16 v122, v65, v37, v122
  v_dot2_f32_bf16 v122, v66, v38, v122
  v_dot2_f32_bf16 v122, v67, v39, v122
  buffer_load_dwordx4 v[104:107], v188, s[8:11], s78 offen nt
  s_waitcnt vmcnt(9)
  v_dot2_f32_bf16 v123, v68, v36, 0
  v_dot2_f32_bf16 v123, v69, v37, v123
  v_dot2_f32_bf16 v123, v70, v38, v123
  v_dot2_f32_bf16 v123, v71, v39, v123
  buffer_load_dwordx4 v[108:111], v189, s[8:11], s78 offen nt
  v_add_f32_dpp v122, v122, v122 row_ror:8 row_mask:0xf bank_mask:0x3
  s_nop 1
  v_add_f32_dpp v122, v123, v123 row_ror:8 row_mask:0xf bank_mask:0xc
  v_add_f32_dpp v120, v120, v120 row_half_mirror row_mask:0xf bank_mask:0x5
  s_nop 0
  v_add_f32_dpp v120, v122, v122 row_half_mirror row_mask:0xf bank_mask:0xa
  s_nop 1
  v_add_f32_dpp v120, v120, v120 quad_perm:[2,3,0,1] row_mask:0xf bank_mask:0xf
  s_waitcnt vmcnt(9)
  v_dot2_f32_bf16 v124, v72, v36, 0
  v_dot2_f32_bf16 v124, v73, v37, v124
  v_dot2_f32_bf16 v124, v74, v38, v124
  v_dot2_f32_bf16 v124, v75, v39, v124
  buffer_load_dwordx4 v[112:115], v190, s[8:11], s78 offen nt
  s_memrealtime s[34:35]
  ds_read_b64 v[8:9], v54 offset:264
  s_waitcnt vmcnt(9)
  v_dot2_f32_bf16 v125, v76, v36, 0
  v_dot2_f32_bf16 v125, v77, v37, v125
  v_dot2_f32_bf16 v125, v78, v38, v125
  v_dot2_f32_bf16 v125, v79, v39, v125
  buffer_load_dwordx4 v[116:119], v191, s[8:11], s78 offen nt
  v_add_f32_dpp v124, v124, v124 row_ror:8 row_mask:0xf bank_mask:0x3
  s_nop 1
  v_add_f32_dpp v124, v125, v125 row_ror:8 row_mask:0xf bank_mask:0xc
L_aft:
  s_add_u32 s61, s61, 1
  v_add_u32 v10, 4, v10
  s_lshl_b32 s62, s4, 24
  s_bfe_u32 s65, s61, 65536
  s_lshl_b32 s65, s65, 17
  s_or_b32 s62, s62, s65
  s_bfe_u32 s65, s61, 327681
  s_lshl_b32 s65, s65, 19
  s_or_b32 s62, s62, s65
  s_add_u32 s78, s62, 262144
  s_waitcnt lgkmcnt(0)
  v_readfirstlane_b32 s65, v8
  v_readfirstlane_b32 s66, v9
  v_or_b32 v11, s34, v53
  ds_write_b32 v10, v11 offset:4672
  s_mul_i32 s66, s66, s61
  s_add_u32 s67, s65, s66
  s_lshl_b32 s66, s34, 4
  s_sub_u32 s70, s66, s67
  s_cmp_eq_u32 s65, s7
  s_cselect_b32 s6, s6, 0
  s_cselect_b32 s63, s63, s70
  s_mov_b32 s7, s65
  s_sub_u32 s66, s70, s63
  s_mov_b32 s63, s70
  s_cmp_gt_i32 s66, 1600
  s_cselect_b32 s66, s66, 0
  s_add_u32 s6, s6, s66
  s_sub_u32 s70, s70, s6
  s_cmp_ge_u32 s61, 64
  s_cbranch_scc1 L_vsel
  s_cmp_lt_i32 s70, 0
  s_cbranch_scc1 L_KS
  s_add_u32 s6, s6, 80
  buffer_load_dwordx4 v[56:59], v184, s[8:11], s62 offen nt
  buffer_load_dwordx4 v[60:63], v185, s[8:11], s62 offen nt
  buffer_load_dwordx4 v[64:67], v186, s[8:11], s62 offen nt
  buffer_load_dwordx4 v[68:71], v187, s[8:11], s62 offen nt
  s_waitcnt vmcnt(13)
  v_dot2_f32_bf16 v126, v80, v36, 0
  v_dot2_f32_bf16 v126, v81, v37, v126
  v_dot2_f32_bf16 v126, v82, v38, v126
  v_dot2_f32_bf16 v126, v83, v39, v126
  buffer_load_dwordx4 v[72:75], v188, s[8:11], s62 offen nt
  s_waitcnt vmcnt(13)
  v_dot2_f32_bf16 v127, v84, v36, 0
  v_dot2_f32_bf16 v127, v85, v37, v127
  v_dot2_f32_bf16 v127, v86, v38, v127
  v_dot2_f32_bf16 v127, v87, v39, v127
  buffer_load_dwordx4 v[76:79], v189, s[8:11], s62 offen nt
  v_add_f32_dpp v126, v126, v126 row_ror:8 row_mask:0xf bank_mask:0x3
  s_nop 1
  v_add_f32_dpp v126, v127, v127 row_ror:8 row_mask:0xf bank_mask:0xc
  v_add_f32_dpp v124, v124, v124 row_half_mirror row_mask:0xf bank_mask:0x5
  s_nop 0
  v_add_f32_dpp v124, v126, v126 row_half_mirror row_mask:0xf bank_mask:0xa
  s_nop 1
  v_add_f32_dpp v124, v124, v124 quad_perm:[2,3,0,1] row_mask:0xf bank_mask:0xf
  v_cndmask_b32_e64 v120, v120, v124, s[72:73]
  s_nop 1
  v_add_f32_dpp v120, v120, v120 quad_perm:[1,0,3,2] row_mask:0xf bank_mask:0xf
  s_waitcnt vmcnt(13)
  v_dot2_f32_bf16 v128, v88, v36, 0
  v_dot2_f32_bf16 v128, v89, v37, v128
  v_dot2_f32_bf16 v128, v90, v38, v128
  v_dot2_f32_bf16 v128, v91, v39, v128
  buffer_load_dwordx4 v[80:83], v190, s[8:11], s62 offen nt
  s_waitcnt vmcnt(13)
  v_dot2_f32_bf16 v129, v92, v36, 0
  v_dot2_f32_bf16 v129, v93, v37, v129
  v_dot2_f32_bf16 v129, v94, v38, v129
  v_dot2_f32_bf16 v129, v95, v39, v129
  buffer_load_dwordx4 v[84:87], v191, s[8:11], s62 offen nt
  v_add_f32_dpp v128, v128, v128 row_ror:8 row_mask:0xf bank_mask:0x3
  s_nop 1
  v_add_f32_dpp v128, v129, v129 row_ror:8 row_mask:0xf bank_mask:0xc
  s_waitcnt vmcnt(13)
  v_dot2_f32_bf16 v130, v96, v36, 0
  v_dot2_f32_bf16 v130, v97, v37, v130
  v_dot2_f32_bf16 v130, v98, v38, v130
  v_dot2_f32_bf16 v130, v99, v39, v130
  buffer_load_dwordx4 v[88:91], v184, s[8:11], s78 offen nt
  s_waitcnt vmcnt(13)
  v_dot2_f32_bf16 v131, v100, v36, 0
  v_dot2_f32_bf16 v131, v101, v37, v131
  v_dot2_f32_bf16 v131, v102, v38, v131
  v_dot2_f32_bf16 v131, v103, v39, v131
  buffer_load_dwordx4 v[92:95], v185, s[8:11], s78 offen nt
  v_add_f32_dpp v130, v130, v130 row_ror:8 row_mask:0xf bank_mask:0x3
  s_nop 1
  v_add_f32_dpp v130, v131, v131 row_ror:8 row_mask:0xf bank_mask:0xc
  v_add_f32_dpp v128, v128, v128 row_half_mirror row_mask:0xf bank_mask:0x5
  s_nop 0
  v_add_f32_dpp v128, v130, v130 row_half_mirror row_mask:0xf bank_mask:0xa
  s_nop 1
  v_add_f32_dpp v128, v128, v128 quad_perm:[2,3,0,1] row_mask:0xf bank_mask:0xf
  s_waitcnt vmcnt(13)
  v_dot2_f32_bf16 v132, v104, v36, 0
  v_dot2_f32_bf16 v132, v105, v37, v132
  v_dot2_f32_bf16 v132, v106, v38, v132
  v_dot2_f32_bf16 v132, v107, v39, v132
  buffer_load_dwordx4 v[96:99], v186, s[8:11], s78 offen nt
  s_waitcnt vmcnt(13)
  v_dot2_f32_bf16 v133, v108, v36, 0
  v_dot2_f32_bf16 v133, v109, v37, v133
  v_dot2_f32_bf16 v133, v110, v38, v133
  v_dot2_f32_bf16 v133, v111, v39, v133
  buffer_load_dwordx4 v[100:103], v187, s[8:11], s78 offen nt
  v_add_f32_dpp v132, v132, v132 row_ror:8 row_mask:0xf bank_mask:0x3
  s_nop 1
  v_add_f32_dpp v132, v133, v133 row_ror:8 row_mask:0xf bank_mask:0xc
  s_waitcnt vmcnt(13)
  v_dot2_f32_bf16 v134, v112, v36, 0
  v_dot2_f32_bf16 v134, v113, v37, v134
  v_dot2_f32_bf16 v134, v114, v38, v134
  v_dot2_f32_bf16 v134, v115, v39, v134
  buffer_load_dwordx4 v[104:107], v188, s[8:11], s78 offen nt
  s_waitcnt vmcnt(13)
  v_dot2_f32_bf16 v135, v116, v36, 0
  v_dot2_f32_bf16 v135, v117, v37, v135
  v_dot2_f32_bf16 v135, v118, v38, v135
  v_dot2_f32_bf16 v135, v119, v39, v135
  buffer_load_dwordx4 v[108:111], v189, s[8:11], s78 offen nt
  v_add_f32_dpp v134, v134, v134 row_ror:8 row_mask:0xf bank_mask:0x3
  s_nop 1
  v_add_f32_dpp v134, v135, v135 row_ror:8 row_mask:0xf bank_mask:0xc
  v_add_f32_dpp v132, v132, v132 row_half_mirror row_mask:0xf bank_mask:0x5
  s_nop 0
  v_add_f32_dpp v132, v134, v134 row_half_mirror row_mask:0xf bank_mask:0xa
  s_nop 1
  v_add_f32_dpp v132, v132, v132 quad_perm:[2,3,0,1] row_mask:0xf bank_mask:0xf
  v_cndmask_b32_e64 v128, v128, v132, s[72:73]
  s_nop 1
  v_add_f32_dpp v128, v128, v128 quad_perm:[1,0,3,2] row_mask:0xf bank_mask:0xf
  v_cndmask_b32_e64 v40, v120, v128, s[28:29]
  v_cvt_pk_bf16_f32 v40, v40, v40
  v_and_b32 v40, s76, v40
  v_mul_f32 v40, s74, v40
  v_cvt_pk_bf16_f32 v40, v40, v40
  v_and_b32 v40, s76, v40
  v_mul_f32 v40, s75, v40
  ds_write_b32 v52, v40 offset:5952
  v_max_f32 v48, v48, v40
  v_add_u32 v52, 256, v52
  s_waitcnt vmcnt(13)
  v_dot2_f32_bf16 v120, v56, v36, 0
  v_dot2_f32_bf16 v120, v57, v37, v120
  v_dot2_f32_bf16 v120, v58, v38, v120
  v_dot2_f32_bf16 v120, v59, v39, v120
  buffer_load_dwordx4 v[112:115], v190, s[8:11], s78 offen nt
  s_waitcnt vmcnt(13)
  v_dot2_f32_bf16 v121, v60, v36, 0
  v_dot2_f32_bf16 v121, v61, v37, v121
  v_dot2_f32_bf16 v121, v62, v38, v121
  v_dot2_f32_bf16 v121, v63, v39, v121
  buffer_load_dwordx4 v[116:119], v191, s[8:11], s78 offen nt
  v_add_f32_dpp v120, v120, v120 row_ror:8 row_mask:0xf bank_mask:0x3
  s_nop 1
  v_add_f32_dpp v120, v121, v121 row_ror:8 row_mask:0xf bank_mask:0xc
  s_waitcnt vmcnt(13)
  v_dot2_f32_bf16 v122, v64, v36, 0
  v_dot2_f32_bf16 v122, v65, v37, v122
  v_dot2_f32_bf16 v122, v66, v38, v122
  v_dot2_f32_bf16 v122, v67, v39, v122
  s_waitcnt vmcnt(12)
  v_dot2_f32_bf16 v123, v68, v36, 0
  v_dot2_f32_bf16 v123, v69, v37, v123
  v_dot2_f32_bf16 v123, v70, v38, v123
  v_dot2_f32_bf16 v123, v71, v39, v123
  v_add_f32_dpp v122, v122, v122 row_ror:8 row_mask:0xf bank_mask:0x3
  s_nop 1
  v_add_f32_dpp v122, v123, v123 row_ror:8 row_mask:0xf bank_mask:0xc
  v_add_f32_dpp v120, v120, v120 row_half_mirror row_mask:0xf bank_mask:0x5
  s_nop 0
  v_add_f32_dpp v120, v122, v122 row_half_mirror row_mask:0xf bank_mask:0xa
  s_nop 1
  v_add_f32_dpp v120, v120, v120 quad_perm:[2,3,0,1] row_mask:0xf bank_mask:0xf
  s_waitcnt vmcnt(11)
  v_dot2_f32_bf16 v124, v72, v36, 0
  v_dot2_f32_bf16 v124, v73, v37, v124
  v_dot2_f32_bf16 v124, v74, v38, v124
  v_dot2_f32_bf16 v124, v75, v39, v124
  s_memrealtime s[34:35]
  ds_read_b64 v[8:9], v54 offset:264
  s_waitcnt vmcnt(10)
  v_dot2_f32_bf16 v125, v76, v36, 0
  v_dot2_f32_bf16 v125, v77, v37, v125
  v_dot2_f32_bf16 v125, v78, v38, v125
  v_dot2_f32_bf16 v125, v79, v39, v125
  v_add_f32_dpp v124, v124, v124 row_ror:8 row_mask:0xf bank_mask:0x3
  s_nop 1
  v_add_f32_dpp v124, v125, v125 row_ror:8 row_mask:0xf bank_mask:0xc
  s_branch L_aft
L_vsel:
  s_and_b32 s65, s61, 63
  s_cbranch_scc0 L_edge
  s_cmp_lt_i32 s70, 0
  s_cbranch_scc0 L_VB
  ds_read_b32 v51, v52 offset:5952
  v_add_u32 v52, 256, v52
  v_and_b32_dpp v24, v50, v196 row_newbcast:6 row_mask:0xf bank_mask:0xf
  v_and_b32_dpp v25, v50, v197 row_newbcast:6 row_mask:0xf bank_mask:0xf
  s_waitcnt vmcnt(9)
  s_nop 0
  v_smfmac_f32_16x16x32_bf16 v[28:31], v[24:25], v[80:83], v198
  buffer_load_dwordx4 v[56:59], v184, s[12:15], s62 offen nt
  v_and_b32_dpp v24, v50, v196 row_newbcast:14 row_mask:0xf bank_mask:0xf
  v_and_b32_dpp v25, v50, v197 row_newbcast:14 row_mask:0xf bank_mask:0xf
  s_waitcnt vmcnt(9)
  s_nop 0
  v_smfmac_f32_16x16x32_bf16 v[28:31], v[24:25], v[84:87], v198
  buffer_load_dwordx4 v[60:63], v185, s[12:15], s62 offen nt
  v_and_b32_dpp v24, v50, v196 row_newbcast:1 row_mask:0xf bank_mask:0xf
  v_and_b32_dpp v25, v50, v197 row_newbcast:1 row_mask:0xf bank_mask:0xf
  s_waitcnt vmcnt(9)
  s_nop 0
  v_smfmac_f32_16x16x32_bf16 v[28:31], v[24:25], v[88:91], v198
  buffer_load_dwordx4 v[64:67], v186, s[12:15], s62 offen nt
  v_and_b32_dpp v24, v50, v196 row_newbcast:9 row_mask:0xf bank_mask:0xf
  v_and_b32_dpp v25, v50, v197 row_newbcast:9 row_mask:0xf bank_mask:0xf
  s_waitcnt vmcnt(9)
  s_nop 0
  v_smfmac_f32_16x16x32_bf16 v[28:31], v[24:25], v[92:95], v198
  buffer_load_dwordx4 v[68:71], v187, s[12:15], s62 offen nt
  v_and_b32_dpp v24, v50, v196 row_newbcast:5 row_mask:0xf bank_mask:0xf
  v_and_b32_dpp v25, v50, v197 row_newbcast:5 row_mask:0xf bank_mask:0xf
  s_waitcnt vmcnt(9)
  s_nop 0
  v_smfmac_f32_16x16x32_bf16 v[28:31], v[24:25], v[96:99], v198
  buffer_load_dwordx4 v[72:75], v188, s[12:15], s62 offen nt
  v_and_b32_dpp v24, v50, v196 row_newbcast:13 row_mask:0xf bank_mask:0xf
  v_and_b32_dpp v25, v50, v197 row_newbcast:13 row_mask:0xf bank_mask:0xf
  s_waitcnt vmcnt(9)
  s_nop 0
  v_smfmac_f32_16x16x32_bf16 v[28:31], v[24:25], v[100:103], v198
  buffer_load_dwordx4 v[76:79], v189, s[12:15], s62 offen nt
  v_and_b32_dpp v24, v50, v196 row_newbcast:3 row_mask:0xf bank_mask:0xf
  v_and_b32_dpp v25, v50, v197 row_newbcast:3 row_mask:0xf bank_mask:0xf
  s_waitcnt vmcnt(9)
  s_nop 0
  v_smfmac_f32_16x16x32_bf16 v[28:31], v[24:25], v[104:107], v198
  buffer_load_dwordx4 v[80:83], v190, s[12:15], s62 offen nt
  v_and_b32_dpp v24, v50, v196 row_newbcast:11 row_mask:0xf bank_mask:0xf
  v_and_b32_dpp v25, v50, v197 row_newbcast:11 row_mask:0xf bank_mask:0xf
  s_waitcnt vmcnt(9)
  s_nop 0
  v_smfmac_f32_16x16x32_bf16 v[28:31], v[24:25], v[108:111], v198
  buffer_load_dwordx4 v[84:87], v191, s[12:15], s62 offen nt
  v_and_b32_dpp v24, v50, v196 row_newbcast:7 row_mask:0xf bank_mask:0xf
  v_and_b32_dpp v25, v50, v197 row_newbcast:7 row_mask:0xf bank_mask:0xf
  s_waitcnt vmcnt(9)
  s_nop 0
  v_smfmac_f32_16x16x32_bf16 v[28:31], v[24:25], v[112:115], v198
  buffer_load_dwordx4 v[88:91], v184, s[12:15], s78 offen nt
  v_and_b32_dpp v24, v50, v196 row_newbcast:15 row_mask:0xf bank_mask:0xf
  v_and_b32_dpp v25, v50, v197 row_newbcast:15 row_mask:0xf bank_mask:0xf
  s_waitcnt vmcnt(9)
  s_nop 0
  v_smfmac_f32_16x16x32_bf16 v[28:31], v[24:25], v[116:119], v198
  buffer_load_dwordx4 v[92:95], v185, s[12:15], s78 offen nt
  s_waitcnt lgkmcnt(0)
  v_sub_f32 v51, v51, v48
  v_exp_f32 v51, v51
  s_nop 0
  v_cvt_pk_bf16_f32 v50, v51, v51
  v_add_f32 v49, v49, v51
  s_nop 0
  v_and_b32_dpp v24, v50, v196 row_newbcast:0 row_mask:0xf bank_mask:0xf
  v_and_b32_dpp v25, v50, v197 row_newbcast:0 row_mask:0xf bank_mask:0xf
  s_waitcnt vmcnt(9)
  s_nop 0
  v_smfmac_f32_16x16x32_bf16 v[28:31], v[24:25], v[56:59], v198
  buffer_load_dwordx4 v[96:99], v186, s[12:15], s78 offen nt
  v_and_b32_dpp v24, v50, v196 row_newbcast:8 row_mask:0xf bank_mask:0xf
  v_and_b32_dpp v25, v50, v197 row_newbcast:8 row_mask:0xf bank_mask:0xf
  s_waitcnt vmcnt(9)
  s_nop 0
  v_smfmac_f32_16x16x32_bf16 v[28:31], v[24:25], v[60:63], v198
  buffer_load_dwordx4 v[100:103], v187, s[12:15], s78 offen nt
  v_and_b32_dpp v24, v50, v196 row_newbcast:4 row_mask:0xf bank_mask:0xf
  v_and_b32_dpp v25, v50, v197 row_newbcast:4 row_mask:0xf bank_mask:0xf
  s_waitcnt vmcnt(9)
  s_nop 0
  v_smfmac_f32_16x16x32_bf16 v[28:31], v[24:25], v[64:67], v198
  buffer_load_dwordx4 v[104:107], v188, s[12:15], s78 offen nt
  v_and_b32_dpp v24, v50, v196 row_newbcast:12 row_mask:0xf bank_mask:0xf
  v_and_b32_dpp v25, v50, v197 row_newbcast:12 row_mask:0xf bank_mask:0xf
  s_waitcnt vmcnt(9)
  s_nop 0
  v_smfmac_f32_16x16x32_bf16 v[28:31], v[24:25], v[68:71], v198
  buffer_load_dwordx4 v[108:111], v189, s[12:15], s78 offen nt
  v_and_b32_dpp v24, v50, v196 row_newbcast:2 row_mask:0xf bank_mask:0xf
  v_and_b32_dpp v25, v50, v197 row_newbcast:2 row_mask:0xf bank_mask:0xf
  s_waitcnt vmcnt(9)
  s_nop 0
  v_smfmac_f32_16x16x32_bf16 v[28:31], v[24:25], v[72:75], v198
  buffer_load_dwordx4 v[112:115], v190, s[12:15], s78 offen nt
  s_memrealtime s[34:35]
  ds_read_b64 v[8:9], v54 offset:264
  v_and_b32_dpp v24, v50, v196 row_newbcast:10 row_mask:0xf bank_mask:0xf
  v_and_b32_dpp v25, v50, v197 row_newbcast:10 row_mask:0xf bank_mask:0xf
  s_waitcnt vmcnt(9)
  s_nop 0
  v_smfmac_f32_16x16x32_bf16 v[28:31], v[24:25], v[76:79], v198
  buffer_load_dwordx4 v[116:119], v191, s[12:15], s78 offen nt
  s_branch L_aft
L_VB:
  s_add_u32 s6, s6, 80
  buffer_load_dwordx4 v[56:59], v184, s[12:15], s62 offen nt
  buffer_load_dwordx4 v[60:63], v185, s[12:15], s62 offen nt
  buffer_load_dwordx4 v[64:67], v186, s[12:15], s62 offen nt
  buffer_load_dwordx4 v[68:71], v187, s[12:15], s62 offen nt
  ds_read_b32 v51, v52 offset:5952
  v_add_u32 v52, 256, v52
  v_and_b32_dpp v24, v50, v196 row_newbcast:6 row_mask:0xf bank_mask:0xf
  v_and_b32_dpp v25, v50, v197 row_newbcast:6 row_mask:0xf bank_mask:0xf
  s_waitcnt vmcnt(13)
  s_nop 0
  v_smfmac_f32_16x16x32_bf16 v[28:31], v[24:25], v[80:83], v198
  buffer_load_dwordx4 v[72:75], v188, s[12:15], s62 offen nt
  v_and_b32_dpp v24, v50, v196 row_newbcast:14 row_mask:0xf bank_mask:0xf
  v_and_b32_dpp v25, v50, v197 row_newbcast:14 row_mask:0xf bank_mask:0xf
  s_waitcnt vmcnt(13)
  s_nop 0
  v_smfmac_f32_16x16x32_bf16 v[28:31], v[24:25], v[84:87], v198
  buffer_load_dwordx4 v[76:79], v189, s[12:15], s62 offen nt
  v_and_b32_dpp v24, v50, v196 row_newbcast:1 row_mask:0xf bank_mask:0xf
  v_and_b32_dpp v25, v50, v197 row_newbcast:1 row_mask:0xf bank_mask:0xf
  s_waitcnt vmcnt(13)
  s_nop 0
  v_smfmac_f32_16x16x32_bf16 v[28:31], v[24:25], v[88:91], v198
  buffer_load_dwordx4 v[80:83], v190, s[12:15], s62 offen nt
  v_and_b32_dpp v24, v50, v196 row_newbcast:9 row_mask:0xf bank_mask:0xf
  v_and_b32_dpp v25, v50, v197 row_newbcast:9 row_mask:0xf bank_mask:0xf
  s_waitcnt vmcnt(13)
  s_nop 0
  v_smfmac_f32_16x16x32_bf16 v[28:31], v[24:25], v[92:95], v198
  buffer_load_dwordx4 v[84:87], v191, s[12:15], s62 offen nt
  v_and_b32_dpp v24, v50, v196 row_newbcast:5 row_mask:0xf bank_mask:0xf
  v_and_b32_dpp v25, v50, v197 row_newbcast:5 row_mask:0xf bank_mask:0xf
  s_waitcnt vmcnt(13)
  s_nop 0
  v_smfmac_f32_16x16x32_bf16 v[28:31], v[24:25], v[96:99], v198
  buffer_load_dwordx4 v[88:91], v184, s[12:15], s78 offen nt
  v_and_b32_dpp v24, v50, v196 row_newbcast:13 row_mask:0xf bank_mask:0xf
  v_and_b32_dpp v25, v50, v197 row_newbcast:13 row_mask:0xf bank_mask:0xf
  s_waitcnt vmcnt(13)
  s_nop 0
  v_smfmac_f32_16x16x32_bf16 v[28:31], v[24:25], v[100:103], v198
  buffer_load_dwordx4 v[92:95], v185, s[12:15], s78 offen nt
  v_and_b32_dpp v24, v50, v196 row_newbcast:3 row_mask:0xf bank_mask:0xf
  v_and_b32_dpp v25, v50, v197 row_newbcast:3 row_mask:0xf bank_mask:0xf
  s_waitcnt vmcnt(13)
  s_nop 0
  v_smfmac_f32_16x16x32_bf16 v[28:31], v[24:25], v[104:107], v198
  buffer_load_dwordx4 v[96:99], v186, s[12:15], s78 offen nt
  v_and_b32_dpp v24, v50, v196 row_newbcast:11 row_mask:0xf bank_mask:0xf
  v_and_b32_dpp v25, v50, v197 row_newbcast:11 row_mask:0xf bank_mask:0xf
  s_waitcnt vmcnt(13)
  s_nop 0
  v_smfmac_f32_16x16x32_bf16 v[28:31], v[24:25], v[108:111], v198
  buffer_load_dwordx4 v[100:103], v187, s[12:15], s78 offen nt
  v_and_b32_dpp v24, v50, v196 row_newbcast:7 row_mask:0xf bank_mask:0xf
  v_and_b32_dpp v25, v50, v197 row_newbcast:7 row_mask:0xf bank_mask:0xf
  s_waitcnt vmcnt(13)
  s_nop 0
  v_smfmac_f32_16x16x32_bf16 v[28:31], v[24:25], v[112:115], v198
  buffer_load_dwordx4 v[104:107], v188, s[12:15], s78 offen nt
  v_and_b32_dpp v24, v50, v196 row_newbcast:15 row_mask:0xf bank_mask:0xf
  v_and_b32_dpp v25, v50, v197 row_newbcast:15 row_mask:0xf bank_mask:0xf
  s_waitcnt vmcnt(13)
  s_nop 0
  v_smfmac_f32_16x16x32_bf16 v[28:31], v[24:25], v[116:119], v198
  buffer_load_dwordx4 v[108:111], v189, s[12:15], s78 offen nt
  s_waitcnt lgkmcnt(0)
  v_sub_f32 v51, v51, v48
  v_exp_f32 v51, v51
  s_nop 0
  v_cvt_pk_bf16_f32 v50, v51, v51
  v_add_f32 v49, v49, v51
  s_nop 0
  v_and_b32_dpp v24, v50, v196 row_newbcast:0 row_mask:0xf bank_mask:0xf
  v_and_b32_dpp v25, v50, v197 row_newbcast:0 row_mask:0xf bank_mask:0xf
  s_waitcnt vmcnt(13)
  s_nop 0
  v_smfmac_f32_16x16x32_bf16 v[28:31], v[24:25], v[56:59], v198
  buffer_load_dwordx4 v[112:115], v190, s[12:15], s78 offen nt
  v_and_b32_dpp v24, v50, v196 row_newbcast:8 row_mask:0xf bank_mask:0xf
  v_and_b32_dpp v25, v50, v197 row_newbcast:8 row_mask:0xf bank_mask:0xf
  s_waitcnt vmcnt(13)
  s_nop 0
  v_smfmac_f32_16x16x32_bf16 v[28:31], v[24:25], v[60:63], v198
  buffer_load_dwordx4 v[116:119], v191, s[12:15], s78 offen nt
  v_and_b32_dpp v24, v50, v196 row_newbcast:4 row_mask:0xf bank_mask:0xf
  v_and_b32_dpp v25, v50, v197 row_newbcast:4 row_mask:0xf bank_mask:0xf
  s_waitcnt vmcnt(13)
  s_nop 0
  v_smfmac_f32_16x16x32_bf16 v[28:31], v[24:25], v[64:67], v198
  v_and_b32_dpp v24, v50, v196 row_newbcast:12 row_mask:0xf bank_mask:0xf
  v_and_b32_dpp v25, v50, v197 row_newbcast:12 row_mask:0xf bank_mask:0xf
  s_waitcnt vmcnt(12)
  s_nop 0
  v_smfmac_f32_16x16x32_bf16 v[28:31], v[24:25], v[68:71], v198
  v_and_b32_dpp v24, v50, v196 row_newbcast:2 row_mask:0xf bank_mask:0xf
  v_and_b32_dpp v25, v50, v197 row_newbcast:2 row_mask:0xf bank_mask:0xf
  s_waitcnt vmcnt(11)
  s_nop 0
  v_smfmac_f32_16x16x32_bf16 v[28:31], v[24:25], v[72:75], v198
  s_memrealtime s[34:35]
  ds_read_b64 v[8:9], v54 offset:264
  v_and_b32_dpp v24, v50, v196 row_newbcast:10 row_mask:0xf bank_mask:0xf
  v_and_b32_dpp v25, v50, v197 row_newbcast:10 row_mask:0xf bank_mask:0xf
  s_waitcnt vmcnt(10)
  s_nop 0
  v_smfmac_f32_16x16x32_bf16 v[28:31], v[24:25], v[76:79], v198
  s_branch L_aft
L_edge:
  s_cmp_eq_u32 s61, 128
  s_cbranch_scc1 L_last
  s_waitcnt vmcnt(9)
  v_dot2_f32_bf16 v126, v80, v36, 0
  v_dot2_f32_bf16 v126, v81, v37, v126
  v_dot2_f32_bf16 v126, v82, v38, v126
  v_dot2_f32_bf16 v126, v83, v39, v126
  buffer_load_dwordx4 v[56:59], v184, s[12:15], s62 offen nt
  s_waitcnt vmcnt(9)
  v_dot2_f32_bf16 v127, v84, v36, 0
  v_dot2_f32_bf16 v127, v85, v37, v127
  v_dot2_f32_bf16 v127, v86, v38, v127
  v_dot2_f32_bf16 v127, v87, v39, v127
  buffer_load_dwordx4 v[60:63], v185, s[12:15], s62 offen nt
  v_add_f32_dpp v126, v126, v126 row_ror:8 row_mask:0xf bank_mask:0x3
  s_nop 1
  v_add_f32_dpp v126, v127, v127 row_ror:8 row_mask:0xf bank_mask:0xc
  v_add_f32_dpp v124, v124, v124 row_half_mirror row_mask:0xf bank_mask:0x5
  s_nop 0
  v_add_f32_dpp v124, v126, v126 row_half_mirror row_mask:0xf bank_mask:0xa
  s_nop 1
  v_add_f32_dpp v124, v124, v124 quad_perm:[2,3,0,1] row_mask:0xf bank_mask:0xf
  v_cndmask_b32_e64 v120, v120, v124, s[72:73]
  s_nop 1
  v_add_f32_dpp v120, v120, v120 quad_perm:[1,0,3,2] row_mask:0xf bank_mask:0xf
  s_waitcnt vmcnt(9)
  v_dot2_f32_bf16 v128, v88, v36, 0
  v_dot2_f32_bf16 v128, v89, v37, v128
  v_dot2_f32_bf16 v128, v90, v38, v128
  v_dot2_f32_bf16 v128, v91, v39, v128
  buffer_load_dwordx4 v[64:67], v186, s[12:15], s62 offen nt
  s_waitcnt vmcnt(9)
  v_dot2_f32_bf16 v129, v92, v36, 0
  v_dot2_f32_bf16 v129, v93, v37, v129
  v_dot2_f32_bf16 v129, v94, v38, v129
  v_dot2_f32_bf16 v129, v95, v39, v129
  buffer_load_dwordx4 v[68:71], v187, s[12:15], s62 offen nt
  v_add_f32_dpp v128, v128, v128 row_ror:8 row_mask:0xf bank_mask:0x3
  s_nop 1
  v_add_f32_dpp v128, v129, v129 row_ror:8 row_mask:0xf bank_mask:0xc
  s_waitcnt vmcnt(9)
  v_dot2_f32_bf16 v130, v96, v36, 0
  v_dot2_f32_bf16 v130, v97, v37, v130
  v_dot2_f32_bf16 v130, v98, v38, v130
  v_dot2_f32_bf16 v130, v99, v39, v130
  buffer_load_dwordx4 v[72:75], v188, s[12:15], s62 offen nt
  s_waitcnt vmcnt(9)
  v_dot2_f32_bf16 v131, v100, v36, 0
  v_dot2_f32_bf16 v131, v101, v37, v131
  v_dot2_f32_bf16 v131, v102, v38, v131
  v_dot2_f32_bf16 v131, v103, v39, v131
  buffer_load_dwordx4 v[76:79], v189, s[12:15], s62 offen nt
  v_add_f32_dpp v130, v130, v130 row_ror:8 row_mask:0xf bank_mask:0x3
  s_nop 1
  v_add_f32_dpp v130, v131, v131 row_ror:8 row_mask:0xf bank_mask:0xc
  v_add_f32_dpp v128, v128, v128 row_half_mirror row_mask:0xf bank_mask:0x5
  s_nop 0
  v_add_f32_dpp v128, v130, v130 row_half_mirror row_mask:0xf bank_mask:0xa
  s_nop 1
  v_add_f32_dpp v128, v128, v128 quad_perm:[2,3,0,1] row_mask:0xf bank_mask:0xf
  s_waitcnt vmcnt(9)
  v_dot2_f32_bf16 v132, v104, v36, 0
  v_dot2_f32_bf16 v132, v105, v37, v132
  v_dot2_f32_bf16 v132, v106, v38, v132
  v_dot2_f32_bf16 v132, v107, v39, v132
  buffer_load_dwordx4 v[80:83], v190, s[12:15], s62 offen nt
  s_waitcnt vmcnt(9)
  v_dot2_f32_bf16 v133, v108, v36, 0
  v_dot2_f32_bf16 v133, v109, v37, v133
  v_dot2_f32_bf16 v133, v110, v38, v133
  v_dot2_f32_bf16 v133, v111, v39, v133
  buffer_load_dwordx4 v[84:87], v191, s[12:15], s62 offen nt
  v_add_f32_dpp v132, v132, v132 row_ror:8 row_mask:0xf bank_mask:0x3
  s_nop 1
  v_add_f32_dpp v132, v133, v133 row_ror:8 row_mask:0xf bank_mask:0xc
  s_waitcnt vmcnt(9)
  v_dot2_f32_bf16 v134, v112, v36, 0
  v_dot2_f32_bf16 v134, v113, v37, v134
  v_dot2_f32_bf16 v134, v114, v38, v134
  v_dot2_f32_bf16 v134, v115, v39, v134
  buffer_load_dwordx4 v[88:91], v184, s[12:15], s78 offen nt
  s_waitcnt vmcnt(9)
  v_dot2_f32_bf16 v135, v116, v36, 0
  v_dot2_f32_bf16 v135, v117, v37, v135
  v_dot2_f32_bf16 v135, v118, v38, v135
  v_dot2_f32_bf16 v135, v119, v39, v135
  buffer_load_dwordx4 v[92:95], v185, s[12:15], s78 offen nt
  v_add_f32_dpp v134, v134, v134 row_ror:8 row_mask:0xf bank_mask:0x3
  s_nop 1
  v_add_f32_dpp v134, v135, v135 row_ror:8 row_mask:0xf bank_mask:0xc
  v_add_f32_dpp v132, v132, v132 row_half_mirror row_mask:0xf bank_mask:0x5
  s_nop 0
  v_add_f32_dpp v132, v134, v134 row_half_mirror row_mask:0xf bank_mask:0xa
  s_nop 1
  v_add_f32_dpp v132, v132, v132 quad_perm:[2,3,0,1] row_mask:0xf bank_mask:0xf
  v_cndmask_b32_e64 v128, v128, v132, s[72:73]
  s_nop 1
  v_add_f32_dpp v128, v128, v128 quad_perm:[1,0,3,2] row_mask:0xf bank_mask:0xf
  v_cndmask_b32_e64 v40, v120, v128, s[28:29]
  v_cvt_pk_bf16_f32 v40, v40, v40
  v_and_b32 v40, s76, v40
  v_mul_f32 v40, s74, v40
  v_cvt_pk_bf16_f32 v40, v40, v40
  v_and_b32 v40, s76, v40
  v_mul_f32 v40, s75, v40
  ds_write_b32 v52, v40 offset:5952
  v_max_f32 v48, v48, v40
  v_add_u32 v52, 256, v52
  v_subrev_u32 v52, 16384, v52
  ds_read_b32 v51, v52 offset:5952
  v_add_u32 v52, 256, v52
  s_nop 1
  v_max_f32_dpp v48, v48, v48 quad_perm:[1,0,3,2] row_mask:0xf bank_mask:0xf
  s_nop 1
  v_max_f32_dpp v48, v48, v48 quad_perm:[2,3,0,1] row_mask:0xf bank_mask:0xf
  s_nop 1
  v_max_f32_dpp v48, v48, v48 row_half_mirror row_mask:0xf bank_mask:0xf
  s_nop 1
  v_max_f32_dpp v48, v48, v48 row_mirror row_mask:0xf bank_mask:0xf
  s_nop 0
  v_readlane_b32 s65, v48, 0
  v_readlane_b32 s66, v48, 16
  v_readlane_b32 s67, v48, 32
  v_readlane_b32 s68, v48, 48
  s_nop 0
  v_mov_b32 v48, s65
  v_max_f32 v48, s66, v48
  v_max_f32 v48, s67, v48
  v_max_f32 v48, s68, v48
  s_waitcnt lgkmcnt(0)
  v_sub_f32 v51, v51, v48
  v_exp_f32 v51, v51
  s_nop 0
  v_cvt_pk_bf16_f32 v50, v51, v51
  v_add_f32 v49, v49, v51
  s_nop 0
  v_and_b32_dpp v24, v50, v196 row_newbcast:0 row_mask:0xf bank_mask:0xf
  v_and_b32_dpp v25, v50, v197 row_newbcast:0 row_mask:0xf bank_mask:0xf
  s_waitcnt vmcnt(9)
  s_nop 0
  v_smfmac_f32_16x16x32_bf16 v[28:31], v[24:25], v[56:59], v198
  buffer_load_dwordx4 v[96:99], v186, s[12:15], s78 offen nt
  v_and_b32_dpp v24, v50, v196 row_newbcast:8 row_mask:0xf bank_mask:0xf
  v_and_b32_dpp v25, v50, v197 row_newbcast:8 row_mask:0xf bank_mask:0xf
  s_waitcnt vmcnt(9)
  s_nop 0
  v_smfmac_f32_16x16x32_bf16 v[28:31], v[24:25], v[60:63], v198
  buffer_load_dwordx4 v[100:103], v187, s[12:15], s78 offen nt
  v_and_b32_dpp v24, v50, v196 row_newbcast:4 row_mask:0xf bank_mask:0xf
  v_and_b32_dpp v25, v50, v197 row_newbcast:4 row_mask:0xf bank_mask:0xf
  s_waitcnt vmcnt(9)
  s_nop 0
  v_smfmac_f32_16x16x32_bf16 v[28:31], v[24:25], v[64:67], v198
  buffer_load_dwordx4 v[104:107], v188, s[12:15], s78 offen nt
  v_and_b32_dpp v24, v50, v196 row_newbcast:12 row_mask:0xf bank_mask:0xf
  v_and_b32_dpp v25, v50, v197 row_newbcast:12 row_mask:0xf bank_mask:0xf
  s_waitcnt vmcnt(9)
  s_nop 0
  v_smfmac_f32_16x16x32_bf16 v[28:31], v[24:25], v[68:71], v198
  buffer_load_dwordx4 v[108:111], v189, s[12:15], s78 offen nt
  v_and_b32_dpp v24, v50, v196 row_newbcast:2 row_mask:0xf bank_mask:0xf
  v_and_b32_dpp v25, v50, v197 row_newbcast:2 row_mask:0xf bank_mask:0xf
  s_waitcnt vmcnt(9)
  s_nop 0
  v_smfmac_f32_16x16x32_bf16 v[28:31], v[24:25], v[72:75], v198
  buffer_load_dwordx4 v[112:115], v190, s[12:15], s78 offen nt
  s_memrealtime s[34:35]
  ds_read_b64 v[8:9], v54 offset:264
  v_and_b32_dpp v24, v50, v196 row_newbcast:10 row_mask:0xf bank_mask:0xf
  v_and_b32_dpp v25, v50, v197 row_newbcast:10 row_mask:0xf bank_mask:0xf
  s_waitcnt vmcnt(9)
  s_nop 0
  v_smfmac_f32_16x16x32_bf16 v[28:31], v[24:25], v[76:79], v198
  buffer_load_dwordx4 v[116:119], v191, s[12:15], s78 offen nt
  s_branch L_aft
L_last:
  v_add_f32_dpp v49, v49, v49 quad_perm:[1,0,3,2] row_mask:0xf bank_mask:0xf
  s_nop 1
  v_add_f32_dpp v49, v49, v49 quad_perm:[2,3,0,1] row_mask:0xf bank_mask:0xf
  s_nop 1
  v_add_f32_dpp v49, v49, v49 row_half_mirror row_mask:0xf bank_mask:0xf
  s_nop 1
  v_add_f32_dpp v49, v49, v49 row_mirror row_mask:0xf bank_mask:0xf
  s_mov_b32 exec_lo, 0x00010001
  s_mov_b32 exec_hi, 0x00010001
  ds_write_b32 v15, v49 offset:3584
  ds_write_b32 v15, v48 offset:3600
  ds_write_b32 v12, v194 offset:304
  s_mov_b64 exec, -1
  v_and_b32_dpp v24, v50, v196 row_newbcast:6 row_mask:0xf bank_mask:0xf
  v_and_b32_dpp v25, v50, v197 row_newbcast:6 row_mask:0xf bank_mask:0xf
  s_waitcnt vmcnt(9)
  s_nop 0
  v_smfmac_f32_16x16x32_bf16 v[28:31], v[24:25], v[80:83], v198
  buffer_load_dwordx4 v[136:139], v3, s[24:27], s69 offen offset:0 nt
  v_and_b32_dpp v24, v50, v196 row_newbcast:14 row_mask:0xf bank_mask:0xf
  v_and_b32_dpp v25, v50, v197 row_newbcast:14 row_mask:0xf bank_mask:0xf
  s_waitcnt vmcnt(9)
  s_nop 0
  v_smfmac_f32_16x16x32_bf16 v[28:31], v[24:25], v[84:87], v198
  buffer_load_dwordx4 v[140:143], v3, s[24:27], s69 offen offset:2048 nt
  v_and_b32_dpp v24, v50, v196 row_newbcast:1 row_mask:0xf bank_mask:0xf
  v_and_b32_dpp v25, v50, v197 row_newbcast:1 row_mask:0xf bank_mask:0xf
  s_waitcnt vmcnt(9)
  s_nop 0
  v_smfmac_f32_16x16x32_bf16 v[28:31], v[24:25], v[88:91], v198
  s_add_u32 s69, s69, 4096
  buffer_load_dwordx4 v[144:147], v3, s[24:27], s69 offen offset:0 nt
  v_and_b32_dpp v24, v50, v196 row_newbcast:9 row_mask:0xf bank_mask:0xf
  v_and_b32_dpp v25, v50, v197 row_newbcast:9 row_mask:0xf bank_mask:0xf
  s_waitcnt vmcnt(9)
  s_nop 0
  v_smfmac_f32_16x16x32_bf16 v[28:31], v[24:25], v[92:95], v198
  buffer_load_dwordx4 v[148:151], v3, s[24:27], s69 offen offset:2048 nt
  v_and_b32_dpp v24, v50, v196 row_newbcast:5 row_mask:0xf bank_mask:0xf
  v_and_b32_dpp v25, v50, v197 row_newbcast:5 row_mask:0xf bank_mask:0xf
  s_waitcnt vmcnt(9)
  s_nop 0
  v_smfmac_f32_16x16x32_bf16 v[28:31], v[24:25], v[96:99], v198
  s_add_u32 s69, s69, 4096
  buffer_load_dwordx4 v[152:155], v3, s[24:27], s69 offen offset:0 nt
  v_and_b32_dpp v24, v50, v196 row_newbcast:13 row_mask:0xf bank_mask:0xf
  v_and_b32_dpp v25, v50, v197 row_newbcast:13 row_mask:0xf bank_mask:0xf
  s_waitcnt vmcnt(9)
  s_nop 0
  v_smfmac_f32_16x16x32_bf16 v[28:31], v[24:25], v[100:103], v198
  buffer_load_dwordx4 v[156:159], v3, s[24:27], s69 offen offset:2048 nt
  v_and_b32_dpp v24, v50, v196 row_newbcast:3 row_mask:0xf bank_mask:0xf
  v_and_b32_dpp v25, v50, v197 row_newbcast:3 row_mask:0xf bank_mask:0xf
  s_waitcnt vmcnt(9)
  s_nop 0
  v_smfmac_f32_16x16x32_bf16 v[28:31], v[24:25], v[104:107], v198
  s_add_u32 s69, s69, 4096
  buffer_load_dwordx4 v[160:163], v3, s[24:27], s69 offen offset:0 nt
  v_and_b32_dpp v24, v50, v196 row_newbcast:11 row_mask:0xf bank_mask:0xf
  v_and_b32_dpp v25, v50, v197 row_newbcast:11 row_mask:0xf bank_mask:0xf
  s_waitcnt vmcnt(9)
  s_nop 0
  v_smfmac_f32_16x16x32_bf16 v[28:31], v[24:25], v[108:111], v198
  buffer_load_dwordx4 v[164:167], v3, s[24:27], s69 offen offset:2048 nt
  v_and_b32_dpp v24, v50, v196 row_newbcast:7 row_mask:0xf bank_mask:0xf
  v_and_b32_dpp v25, v50, v197 row_newbcast:7 row_mask:0xf bank_mask:0xf
  s_waitcnt vmcnt(9)
  s_nop 0
  v_smfmac_f32_16x16x32_bf16 v[28:31], v[24:25], v[112:115], v198
  s_add_u32 s69, s69, 4096
  buffer_load_dwordx4 v[168:171], v3, s[24:27], s69 offen offset:0 nt
  v_and_b32_dpp v24, v50, v196 row_newbcast:15 row_mask:0xf bank_mask:0xf
  v_and_b32_dpp v25, v50, v197 row_newbcast:15 row_mask:0xf bank_mask:0xf
  s_waitcnt vmcnt(9)
  s_nop 0
  v_smfmac_f32_16x16x32_bf16 v[28:31], v[24:25], v[116:119], v198
  buffer_load_dwordx4 v[172:175], v3, s[24:27], s69 offen offset:2048 nt
  s_nop 9
  s_mov_b32 exec_lo, -1
  s_mov_b32 exec_hi, 0
  ds_write_b128 v14, v[28:31] offset:2560
  ds_write_b32 v12, v194 offset:272
  s_mov_b64 exec, -1
  s_cmp_eq_u32 s26, 0
  s_cbranch_scc1 L_sdone
  s_add_u32 s69, s69, 4096
  buffer_load_dwordx4 v[176:179], v3, s[24:27], s69 offen offset:0 nt
  s_waitcnt vmcnt(10)
  buffer_load_dwordx4 v[180:183], v3, s[24:27], s69 offen offset:2048 nt
  s_waitcnt vmcnt(10)
  s_add_u32 s69, s69, 4096
  buffer_load_dwordx4 v[120:123], v3, s[24:27], s69 offen offset:0 nt
  s_waitcnt vmcnt(10)
  buffer_load_dwordx4 v[124:127], v3, s[24:27], s69 offen offset:2048 nt
  s_waitcnt vmcnt(10)
  s_add_u32 s69, s69, 4096
  buffer_load_dwordx4 v[128:131], v3, s[24:27], s69 offen offset:0 nt
  s_waitcnt vmcnt(10)
  buffer_load_dwordx4 v[132:135], v3, s[24:27], s69 offen offset:2048 nt
  s_waitcnt vmcnt(10)
  s_add_u32 s69, s69, s60
  buffer_load_dwordx4 v[56:59], v3, s[24:27], s69 offen offset:0 nt
  s_waitcnt vmcnt(10)
  buffer_load_dwordx4 v[60:63], v3, s[24:27], s69 offen offset:2048 nt
  s_waitcnt vmcnt(10)
  s_add_u32 s69, s69, 4096
  buffer_load_dwordx4 v[64:67], v3, s[24:27], s69 offen offset:0 nt
  s_waitcnt vmcnt(10)
  buffer_load_dwordx4 v[68:71], v3, s[24:27], s69 offen offset:2048 nt
  s_waitcnt vmcnt(10)
  s_add_u32 s69, s69, 4096
  buffer_load_dwordx4 v[72:75], v3, s[24:27], s69 offen offset:0 nt
  s_waitcnt vmcnt(10)
  buffer_load_dwordx4 v[76:79], v3, s[24:27], s69 offen offset:2048 nt
  s_waitcnt vmcnt(10)
  s_add_u32 s69, s69, 4096
  buffer_load_dwordx4 v[80:83], v3, s[24:27], s69 offen offset:0 nt
  s_waitcnt vmcnt(10)
  buffer_load_dwordx4 v[84:87], v3, s[24:27], s69 offen offset:2048 nt
  s_waitcnt vmcnt(10)
  s_add_u32 s69, s69, 4096
  buffer_load_dwordx4 v[88:91], v3, s[24:27], s69 offen offset:0 nt
  s_waitcnt vmcnt(10)
  buffer_load_dwordx4 v[92:95], v3, s[24:27], s69 offen offset:2048 nt
  s_waitcnt vmcnt(10)
  s_add_u32 s69, s69, 4096
  buffer_load_dwordx4 v[96:99], v3, s[24:27], s69 offen offset:0 nt
  s_waitcnt vmcnt(10)
  buffer_load_dwordx4 v[100:103], v3, s[24:27], s69 offen offset:2048 nt
  s_waitcnt vmcnt(10)
  s_add_u32 s69, s69, 4096
  buffer_load_dwordx4 v[104:107], v3, s[24:27], s69 offen offset:0 nt
  s_waitcnt vmcnt(10)
  buffer_load_dwordx4 v[108:111], v3, s[24:27], s69 offen offset:2048 nt
  s_waitcnt vmcnt(10)
  s_add_u32 s69, s69, 4096
  buffer_load_dwordx4 v[112:115], v3, s[24:27], s69 offen offset:0 nt
  s_waitcnt vmcnt(10)
  buffer_load_dwordx4 v[116:119], v3, s[24:27], s69 offen offset:2048 nt
  s_mov_b32 s63, 8388608
L_lwV:
  ds_read_b32 v17, v12 offset:280
  ds_read_b64 v[50:51], v13 offset:3648
  ds_read_b32 v18, v54 offset:296
  s_sub_u32 s63, s63, 1
  s_waitcnt lgkmcnt(0)
  s_cbranch_scc1 L_lwokV
  v_cmp_eq_u32 vcc, 0, v17
  s_cbranch_vccnz L_lwV
L_lwokV:
  v_mov_b32 v28, 0
  v_mov_b32 v29, 0
  v_mov_b32 v30, 0
  v_mov_b32 v31, 0
  v_and_b32_dpp v24, v50, v196 row_newbcast:0 row_mask:0xf bank_mask:0xf
  v_and_b32_dpp v25, v50, v197 row_newbcast:0 row_mask:0xf bank_mask:0xf
  v_and_b32_dpp v26, v51, v196 row_newbcast:0 row_mask:0xf bank_mask:0xf
  v_and_b32_dpp v27, v51, v197 row_newbcast:0 row_mask:0xf bank_mask:0xf
  v_smfmac_f32_16x16x32_bf16 v[28:31], v[24:25], v[136:139], v198
  v_and_b32_dpp v24, v50, v196 row_newbcast:1 row_mask:0xf bank_mask:0xf
  v_and_b32_dpp v25, v50, v197 row_newbcast:1 row_mask:0xf bank_mask:0xf
  v_smfmac_f32_16x16x32_bf16 v[28:31], v[26:27], v[140:143], v198
  v_and_b32_dpp v26, v51, v196 row_newbcast:1 row_mask:0xf bank_mask:0xf
  v_and_b32_dpp v27, v51, v197 row_newbcast:1 row_mask:0xf bank_mask:0xf
  v_smfmac_f32_16x16x32_bf16 v[28:31], v[24:25], v[144:147], v198
  v_and_b32_dpp v24, v50, v196 row_newbcast:2 row_mask:0xf bank_mask:0xf
  v_and_b32_dpp v25, v50, v197 row_newbcast:2 row_mask:0xf bank_mask:0xf
  v_smfmac_f32_16x16x32_bf16 v[28:31], v[26:27], v[148:151], v198
  v_and_b32_dpp v26, v51, v196 row_newbcast:2 row_mask:0xf bank_mask:0xf
  v_and_b32_dpp v27, v51, v197 row_newbcast:2 row_mask:0xf bank_mask:0xf
  v_smfmac_f32_16x16x32_bf16 v[28:31], v[24:25], v[152:155], v198
  v_and_b32_dpp v24, v50, v196 row_newbcast:3 row_mask:0xf bank_mask:0xf
  v_and_b32_dpp v25, v50, v197 row_newbcast:3 row_mask:0xf bank_mask:0xf
  v_smfmac_f32_16x16x32_bf16 v[28:31], v[26:27], v[156:159], v198
  v_and_b32_dpp v26, v51, v196 row_newbcast:3 row_mask:0xf bank_mask:0xf
  v_and_b32_dpp v27, v51, v197 row_newbcast:3 row_mask:0xf bank_mask:0xf
  v_smfmac_f32_16x16x32_bf16 v[28:31], v[24:25], v[160:163], v198
  v_and_b32_dpp v24, v50, v196 row_newbcast:4 row_mask:0xf bank_mask:0xf
  v_and_b32_dpp v25, v50, v197 row_newbcast:4 row_mask:0xf bank_mask:0xf
  v_smfmac_f32_16x16x32_bf16 v[28:31], v[26:27], v[164:167], v198
  v_and_b32_dpp v26, v51, v196 row_newbcast:4 row_mask:0xf bank_mask:0xf
  v_and_b32_dpp v27, v51, v197 row_newbcast:4 row_mask:0xf bank_mask:0xf
  v_smfmac_f32_16x16x32_bf16 v[28:31], v[24:25], v[168:171], v198
  v_and_b32_dpp v24, v50, v196 row_newbcast:5 row_mask:0xf bank_mask:0xf
  v_and_b32_dpp v25, v50, v197 row_newbcast:5 row_mask:0xf bank_mask:0xf
  v_smfmac_f32_16x16x32_bf16 v[28:31], v[26:27], v[172:175], v198
  v_and_b32_dpp v26, v51, v196 row_newbcast:5 row_mask:0xf bank_mask:0xf
  v_and_b32_dpp v27, v51, v197 row_newbcast:5 row_mask:0xf bank_mask:0xf
  v_smfmac_f32_16x16x32_bf16 v[28:31], v[24:25], v[176:179], v198
  v_and_b32_dpp v24, v50, v196 row_newbcast:6 row_mask:0xf bank_mask:0xf
  v_and_b32_dpp v25, v50, v197 row_newbcast:6 row_mask:0xf bank_mask:0xf
  v_smfmac_f32_16x16x32_bf16 v[28:31], v[26:27], v[180:183], v198
  v_and_b32_dpp v26, v51, v196 row_newbcast:6 row_mask:0xf bank_mask:0xf
  v_and_b32_dpp v27, v51, v197 row_newbcast:6 row_mask:0xf bank_mask:0xf
  v_smfmac_f32_16x16x32_bf16 v[28:31], v[24:25], v[120:123], v198
  v_and_b32_dpp v24, v50, v196 row_newbcast:7 row_mask:0xf bank_mask:0xf
  v_and_b32_dpp v25, v50, v197 row_newbcast:7 row_mask:0xf bank_mask:0xf
  v_smfmac_f32_16x16x32_bf16 v[28:31], v[26:27], v[124:127], v198
  v_and_b32_dpp v26, v51, v196 row_newbcast:7 row_mask:0xf bank_mask:0xf
  v_and_b32_dpp v27, v51, v197 row_newbcast:7 row_mask:0xf bank_mask:0xf
  v_smfmac_f32_16x16x32_bf16 v[28:31], v[24:25], v[128:131], v198
  v_and_b32_dpp v24, v50, v196 row_newbcast:8 row_mask:0xf bank_mask:0xf
  v_and_b32_dpp v25, v50, v197 row_newbcast:8 row_mask:0xf bank_mask:0xf
  v_smfmac_f32_16x16x32_bf16 v[28:31], v[26:27], v[132:135], v198
  v_and_b32_dpp v26, v51, v196 row_newbcast:8 row_mask:0xf bank_mask:0xf
  v_and_b32_dpp v27, v51, v197 row_newbcast:8 row_mask:0xf bank_mask:0xf
  v_smfmac_f32_16x16x32_bf16 v[28:31], v[24:25], v[56:59], v198
  v_and_b32_dpp v24, v50, v196 row_newbcast:9 row_mask:0xf bank_mask:0xf
  v_and_b32_dpp v25, v50, v197 row_newbcast:9 row_mask:0xf bank_mask:0xf
  v_smfmac_f32_16x16x32_bf16 v[28:31], v[26:27], v[60:63], v198
  v_and_b32_dpp v26, v51, v196 row_newbcast:9 row_mask:0xf bank_mask:0xf
  v_and_b32_dpp v27, v51, v197 row_newbcast:9 row_mask:0xf bank_mask:0xf
  v_smfmac_f32_16x16x32_bf16 v[28:31], v[24:25], v[64:67], v198
  v_and_b32_dpp v24, v50, v196 row_newbcast:10 row_mask:0xf bank_mask:0xf
  v_and_b32_dpp v25, v50, v197 row_newbcast:10 row_mask:0xf bank_mask:0xf
  v_smfmac_f32_16x16x32_bf16 v[28:31], v[26:27], v[68:71], v198
  v_and_b32_dpp v26, v51, v196 row_newbcast:10 row_mask:0xf bank_mask:0xf
  v_and_b32_dpp v27, v51, v197 row_newbcast:10 row_mask:0xf bank_mask:0xf
  v_smfmac_f32_16x16x32_bf16 v[28:31], v[24:25], v[72:75], v198
  v_and_b32_dpp v24, v50, v196 row_newbcast:11 row_mask:0xf bank_mask:0xf
  v_and_b32_dpp v25, v50, v197 row_newbcast:11 row_mask:0xf bank_mask:0xf
  s_waitcnt vmcnt(10)
  v_smfmac_f32_16x16x32_bf16 v[28:31], v[26:27], v[76:79], v198
  v_and_b32_dpp v26, v51, v196 row_newbcast:11 row_mask:0xf bank_mask:0xf
  v_and_b32_dpp v27, v51, v197 row_newbcast:11 row_mask:0xf bank_mask:0xf
  s_waitcnt vmcnt(9)
  v_smfmac_f32_16x16x32_bf16 v[28:31], v[24:25], v[80:83], v198
  v_and_b32_dpp v24, v50, v196 row_newbcast:12 row_mask:0xf bank_mask:0xf
  v_and_b32_dpp v25, v50, v197 row_newbcast:12 row_mask:0xf bank_mask:0xf
  s_waitcnt vmcnt(8)
  v_smfmac_f32_16x16x32_bf16 v[28:31], v[26:27], v[84:87], v198
  v_and_b32_dpp v26, v51, v196 row_newbcast:12 row_mask:0xf bank_mask:0xf
  v_and_b32_dpp v27, v51, v197 row_newbcast:12 row_mask:0xf bank_mask:0xf
  s_waitcnt vmcnt(7)
  v_smfmac_f32_16x16x32_bf16 v[28:31], v[24:25], v[88:91], v198
  v_and_b32_dpp v24, v50, v196 row_newbcast:13 row_mask:0xf bank_mask:0xf
  v_and_b32_dpp v25, v50, v197 row_newbcast:13 row_mask:0xf bank_mask:0xf
  s_waitcnt vmcnt(6)
  v_smfmac_f32_16x16x32_bf16 v[28:31], v[26:27], v[92:95], v198
  v_and_b32_dpp v26, v51, v196 row_newbcast:13 row_mask:0xf bank_mask:0xf
  v_and_b32_dpp v27, v51, v197 row_newbcast:13 row_mask:0xf bank_mask:0xf
  s_waitcnt vmcnt(5)
  v_smfmac_f32_16x16x32_bf16 v[28:31], v[24:25], v[96:99], v198
  v_and_b32_dpp v24, v50, v196 row_newbcast:14 row_mask:0xf bank_mask:0xf
  v_and_b32_dpp v25, v50, v197 row_newbcast:14 row_mask:0xf bank_mask:0xf
  s_waitcnt vmcnt(4)
  v_smfmac_f32_16x16x32_bf16 v[28:31], v[26:27], v[100:103], v198
  v_and_b32_dpp v26, v51, v196 row_newbcast:14 row_mask:0xf bank_mask:0xf
  v_and_b32_dpp v27, v51, v197 row_newbcast:14 row_mask:0xf bank_mask:0xf
  s_waitcnt vmcnt(3)
  v_smfmac_f32_16x16x32_bf16 v[28:31], v[24:25], v[104:107], v198
  v_and_b32_dpp v24, v50, v196 row_newbcast:15 row_mask:0xf bank_mask:0xf
  v_and_b32_dpp v25, v50, v197 row_newbcast:15 row_mask:0xf bank_mask:0xf
  s_waitcnt vmcnt(2)
  v_smfmac_f32_16x16x32_bf16 v[28:31], v[26:27], v[108:111], v198
  v_and_b32_dpp v26, v51, v196 row_newbcast:15 row_mask:0xf bank_mask:0xf
  v_and_b32_dpp v27, v51, v197 row_newbcast:15 row_mask:0xf bank_mask:0xf
  s_waitcnt vmcnt(1)
  v_smfmac_f32_16x16x32_bf16 v[28:31], v[24:25], v[112:115], v198
  s_nop 1
  s_waitcnt vmcnt(0)
  v_smfmac_f32_16x16x32_bf16 v[28:31], v[26:27], v[116:119], v198
  v_readfirstlane_b32 s65, v18
  v_mov_b32 v19, 0x100
  s_nop 9
  v_bfi_b32 v28, v194, v192, v28
  v_bfi_b32 v29, v194, v192, v29
  v_bfi_b32 v30, v194, v192, v30
  v_bfi_b32 v31, v194, v192, v31
  v_bfi_b32 v28, v19, v18, v28
  s_mov_b32 exec_hi, 0
  s_cmp_lg_u32 s65, 0
  s_cbranch_scc1 L_pubfar
  buffer_store_dwordx4 v[28:31], v55, s[20:23], s64 offen
  s_branch L_pubdone
L_pubfar:
  buffer_store_dwordx4 v[28:31], v55, s[20:23], s64 offen sc1
L_pubdone:
  s_mov_b32 exec_hi, -1
  ds_write_b32 v12, v194 offset:288
L_sdone:
  s_endpgm
L_codeend:
.section .rodata,"a"
.p2align 6
.amdhsa_kernel parallel_sum__mha_block_cached__glu_gated_geglu__decode_kernel
  .amdhsa_next_free_vgpr 204
  .amdhsa_next_free_sgpr 80
  .amdhsa_accum_offset 204
  .amdhsa_group_segment_fixed_size 0
  .amdhsa_kernarg_size 96
  .amdhsa_user_sgpr_count 2
  .amdhsa_user_sgpr_kernarg_segment_ptr 1
  .amdhsa_system_sgpr_workgroup_id_x 1
  .amdhsa_float_denorm_mode_32 3
.end_amdhsa_kernel
```
